```python
import torch

def _softmax(x, axis=-1):
    return torch.softmax(x, dim=axis)
def _gelu(x):
    return torch.nn.functional.gelu(x, approximate="tanh")
def _silu(x):
    return torch.nn.functional.silu(x)
def _sigmoid(x):
    return torch.sigmoid(x)
def _layernorm(x, axis=-1, eps=1e-5):
    m = x.mean(dim=axis, keepdim=True)
    v = x.var(dim=axis, keepdim=True, unbiased=False)
    return (x - m) / torch.sqrt(v + eps)
def _scatter_add(tgt, idx, src, axis=0):
    return tgt.clone().index_add_(axis, idx, src)
def _segment_sum(src, seg, n):
    out = torch.zeros((n,) + src.shape[1:], dtype=src.dtype)
    return out.index_add_(0, seg, src)
def _pad(x, pw):
    flat = tuple(v for pair in reversed(pw) for v in pair)
    return torch.nn.functional.pad(x, flat)

kernel_name = 'gated_mix__ssm_conv_h3__dense_activation_relu__prompt'

def setup_inputs():

    _w = (lambda a: (lambda t: t.to(torch.bfloat16) if t.is_floating_point() else t)(torch.as_tensor(a)))
    def _A_setup():
        B, S, D = 1, 2048, 1024
        ks = 4
        return {
            "q": _w((lambda *s: torch.randn(*s, dtype=torch.bfloat16) * 0.05)(B, S, D)),
            "k": _w((lambda *s: torch.randn(*s, dtype=torch.bfloat16) * 0.8)(B, S, D)),
            "v": _w((lambda *s: torch.randn(*s, dtype=torch.bfloat16) * 0.8)(B, S, D)),
            "shift_k": _w((lambda *s: torch.randn(*s, dtype=torch.bfloat16) * 0.8)(D, ks) * 0.5),
            "ssm_k": _w((lambda *s: torch.randn(*s, dtype=torch.bfloat16) * 0.8)(D, S) * (1.0 / S ** 0.5)),
            "ssm_D": _w((lambda *s: torch.randn(*s, dtype=torch.bfloat16) * 0.8)(D)),
        }
    _A_in = _A_setup()

    def _B_setup():
        B, S, D, Dff = 1, 2048, 1024, 3584
        return {
            "x": _w((lambda *s: torch.randn(*s, dtype=torch.bfloat16) * 0.05)(B, S, D)),
            "w1": _w((lambda *s: torch.randn(*s, dtype=torch.bfloat16) * 0.05)(D, Dff)),
            "w2": _w((lambda *s: torch.randn(*s, dtype=torch.bfloat16) * 0.05)(Dff, D)),
        }
    _B_in = _B_setup()

    return {
        "A_q": _A_in["q"],
        "A_k": _A_in["k"],
        "A_v": _A_in["v"],
        "A_shift_k": _A_in["shift_k"],
        "A_ssm_k": _A_in["ssm_k"],
        "A_ssm_D": _A_in["ssm_D"],
        "B_x": _B_in["x"],
        "B_w1": _B_in["w1"],
        "B_w2": _B_in["w2"],
        "gate_w": _w((lambda *s: torch.randn(*s, dtype=torch.bfloat16) * 0.05)(1024) * 16.0),
    }

def reference(A_q, A_k, A_v, A_shift_k, A_ssm_k, A_ssm_D, B_x, B_w1, B_w2, gate_w):
    def _A_ref(q, k, v, shift_k, ssm_k, ssm_D):
        B, S, D = q.shape
        ks = shift_k.shape[-1]
        k_pad = _pad(k, ((0, 0), (ks - 1, 0), (0, 0)))
        k_shift = torch.zeros_like(k)
        for t in range(ks):
            k_shift = k_shift + k_pad[:, t:t + S, :] * shift_k[:, ks - 1 - t][None, None, :]
        kv = k_shift * v
        L = 2 * S
        kv_pad = _pad(kv, ((0, 0), (0, S), (0, 0)))
        kf_pad = _pad(ssm_k, ((0, 0), (0, S)))
        kv_f = (lambda x, axes=(-2,-1): torch.fft.rfft2(x.float(), dim=axes))(kv_pad[:, None, :, :], axes=(1, 2))
        kf_f = (lambda x, axes=(-2,-1): torch.fft.rfft2(x.float(), dim=axes))(kf_pad[:, None, :], axes=(1, 2))
        kf_f = (lambda x, *d: x.permute(*d))(kf_f, 1, 2, 0)
        y_f = kv_f * kf_f[None, :, :, :]
        y = (lambda x, s, axes=(-2,-1): torch.fft.irfft2(x, s=s, dim=axes).to(torch.bfloat16))(y_f, (1, L), axes=(1, 2))[:, 0, :S, :]
        y = y + kv * ssm_D[None, None, :]
        return q * y

    def _B_ref(x, w1, w2):
        h = torch.einsum("bsd,df->bsf", x, w1)
        zero = torch.zeros_like(h)
        h = torch.maximum(h, zero)
        return torch.einsum("bsf,fd->bsd", h, w2)

    x = A_q
    g = _sigmoid((x * gate_w).sum(-1, keepdims=True))
    a = _A_ref(x, A_k, A_v, A_shift_k, A_ssm_k, A_ssm_D)
    b = _B_ref(x, B_w1, B_w2)
    return g * a + (1 - g) * b
```

```asm
; @launch grid=(256,1,1) block=(512,1,1) lds=163840
.amdgcn_target "amdgcn-amd-amdhsa--gfx950"
.text
.globl gated_mix__ssm_conv_h3__dense_activation_relu__prompt_kernel
.p2align 8
.type gated_mix__ssm_conv_h3__dense_activation_relu__prompt_kernel,@function
gated_mix__ssm_conv_h3__dense_activation_relu__prompt_kernel:
    s_cmp_ge_u32 s2, 256
    s_cbranch_scc1 L_end
    s_load_dwordx16 s[4:19], s[0:1], 0
    s_load_dwordx8 s[20:27], s[0:1], 64
    s_load_dwordx2 s[28:29], s[0:1], 96
    v_lshrrev_b32 v1, 6, v0
    v_and_b32 v0, 63, v0
    s_mov_b32 s60, s2
    s_and_b32 s63, s2, 1
    s_lshr_b32 s64, s2, 5
    s_lshl_b32 s62, s63, 3
    s_add_u32 s62, s62, s64
    s_and_b32 s61, s2, 6
    s_lshl_b32 s61, s61, 1
    s_bfe_u32 s66, s2, 0x20003
    s_add_u32 s61, s61, s66
    v_readfirstlane_b32 s2, v1
    s_add_u32 s66, s61, s64
    s_and_b32 s66, s66, 3
    s_and_b32 s67, s61, 12
    s_add_u32 s67, s67, s62
    s_and_b32 s67, s67, 12
    s_or_b32 s101, s66, s67
    s_lshl_b32 s101, s101, 2
    s_and_b32 s65, s2, 3
    s_cmp_eq_u32 s64, 7
    s_cbranch_scc1 L_P0
    s_cmp_lt_u32 s2, 4
    s_cbranch_scc0 L_B0
    s_mov_b64 exec, 0
    s_cmp_eq_u32 s2, 1
    s_cbranch_scc1 HS0
    s_cmp_eq_u32 s2, 2
    s_cbranch_scc1 HS1
    s_cmp_eq_u32 s2, 3
    s_cbranch_scc1 HS2
    s_mov_b64 exec, -1
    s_getpc_b64 s[48:49]
L_pc:
    s_sub_u32 s48, s48, L_pc-gated_mix__ssm_conv_h3__dense_activation_relu__prompt_kernel
    s_subb_u32 s49, s49, 0
    s_mov_b32 s50, L_end-gated_mix__ssm_conv_h3__dense_activation_relu__prompt_kernel
    s_mov_b32 s51, 0x20000
    s_lshr_b32 s66, s60, 3
    s_mul_i32 s66, s66, 1024
    v_lshlrev_b32 v1, 7, v0
    s_mov_b64 exec, 255
    buffer_load_dword v251, v1, s[48:51], s66 offen
    s_mov_b64 exec, -1
    s_branch L_A0
L_B0:
    s_lshl_b32 s66, s61, 7
    s_lshl_b32 s67, s65, 5
    s_add_u32 s66, s66, s67
    v_lshrrev_b32 v2, 3, v0
    v_add_u32 v2, s66, v2
    v_and_b32 v3, 7, v0
    v_lshrrev_b32 v4, 4, v0
    v_xor_b32 v3, v3, v4
    v_lshlrev_b32 v3, 4, v3
    v_lshl_add_u32 v244, v2, 11, v3
    v_xor_b32 v5, 64, v244
    v_add_u32 v245, 15360, v5
    v_add_u32 v246, 30720, v244
    v_add_u32 v247, 46080, v5
    s_sub_u32 s66, s62, s63
    s_lshl_b32 s66, s66, 9
    s_mul_i32 s67, s65, 57344
    s_add_u32 s66, s66, s67
    s_and_b32 s67, s65, 1
    s_lshl_b32 s67, s67, 3
    v_lshrrev_b32 v2, 5, v0
    v_and_b32 v3, 31, v0
    v_lshl_add_u32 v4, v2, 1, s67
    v_xor_b32 v3, v3, v4
    v_mul_u32_u24 v2, 7168, v2
    v_lshl_add_u32 v2, v3, 4, v2
    v_add_u32 v248, s66, v2
    v_add_u32 v252, 229376, v248
    s_lshl_b32 s69, s65, 12
    s_add_u32 s69, s69, 16384
    s_add_u32 s68, s69, 16384
    v_xor_b32 v2, 64, v248
    v_add_u32 v249, 13312, v2
    v_add_u32 v250, 26624, v248
    v_add_u32 v251, 39936, v2
    v_xor_b32 v2, 64, v252
    v_add_u32 v253, 13312, v2
    v_add_u32 v254, 26624, v252
    v_add_u32 v255, 39936, v2
    s_mov_b32 s70, 0
    s_mov_b32 s71, 0
    s_lshr_b64 s[70:71], s[70:71], s101
    s_and_b32 s31, s70, 15
    s_lshl_b32 s30, s31, 7
    s_mul_i32 s31, s31, 458752
    s_lshl_b32 s3, s65, 12
    s_mov_b32 m0, s3
    s_waitcnt lgkmcnt(0)
    s_mov_b32 s32, s4
    s_mov_b32 s33, s5
    s_mov_b32 s34, 4194304
    s_mov_b32 s35, 0x20000
    s_mov_b32 s36, s18
    s_mov_b32 s37, s19
    s_mov_b32 s38, 7340032
    s_mov_b32 s39, 0x20000
    buffer_load_dwordx4 v244, s[32:35], s30 offen offset:0 lds
    buffer_load_dwordx4 v245, s[32:35], s30 offen offset:1024 lds
    buffer_load_dwordx4 v246, s[32:35], s30 offen offset:2048 lds
    buffer_load_dwordx4 v247, s[32:35], s30 offen offset:3072 lds
    s_mov_b32 m0, s69
    s_mov_b32 s10, s69
    buffer_load_dwordx4 v248, s[36:39], s31 offen offset:0 lds
    buffer_load_dwordx4 v249, s[36:39], s31 offen offset:1024 lds
    buffer_load_dwordx4 v250, s[36:39], s31 offen offset:2048 lds
    buffer_load_dwordx4 v251, s[36:39], s31 offen offset:3072 lds
    s_mov_b32 s11, s68
    s_mov_b32 s9, 98304
L_cs:
    s_mov_b32 s40, s28
    s_mov_b32 s41, s29
    s_mov_b32 s42, 50331648
    s_mov_b32 s43, 0x20000
    s_mov_b32 s56, s26
    s_mov_b32 s57, s27
    s_mov_b32 s58, 256
    s_mov_b32 s59, 0x20000
    s_mov_b32 s44, s12
    s_mov_b32 s45, s13
    s_mov_b32 s46, 4194304
    s_mov_b32 s47, 0x20000
    s_mov_b32 s48, s20
    s_mov_b32 s49, s21
    s_mov_b32 s50, 7340032
    s_mov_b32 s51, 0x20000
    s_mov_b32 s52, s22
    s_mov_b32 s53, s23
    s_mov_b32 s54, 2048
    s_mov_b32 s55, 0x20000
    v_and_b32 v2, 15, v0
    v_lshrrev_b32 v3, 4, v0
    v_and_b32 v32, 3, v0
    v_lshrrev_b32 v33, 2, v2
    v_lshlrev_b32 v1, 4, v0
    s_lshl_b32 s3, s65, 12
    s_lshl_b32 s8, s65, 4
    s_lshl_b32 s6, s62, 4
    s_add_u32 s6, s6, s61
    s_lshl_b32 s66, s6, 3
    s_add_u32 s14, s14, s66
    s_addc_u32 s15, s15, 0
    s_load_dwordx2 s[18:19], s[14:15], 0
    s_lshl_b32 s6, s6, 14
    s_add_u32 s6, s6, s3
    s_mul_i32 s7, s65, 4128
    s_add_u32 s7, s7, 98368
    s_lshl_b32 s5, s60, 14
    s_add_u32 s5, s5, s3
    s_add_u32 s5, s5, 33554432
    v_lshl_add_u32 v34, v2, 1, 1
    v_sub_u32 v34, v34, v3
    v_and_b32 v35, -4, v34
    v_bfe_u32 v36, v34, 1, 1
    v_or_b32 v35, v35, v36
    v_and_b32 v34, 1, v34
    v_lshl_add_u32 v34, v34, 1, v35
    v_lshlrev_b32 v34, 6, v34
    v_add_u32 v4, 118784, v34
    v_lshl_add_u32 v34, v3, 3, v2
    v_and_b32 v35, 1, v2
    v_xor_b32 v35, 1, v35
    v_mul_u32_u24 v35, 48962, v35
    v_lshl_add_u32 v34, v34, 1, v35
    v_add_u32 v34, s7, v34
    v_add_u32 v8, 2, v34
    v_add_u32 v9, 1026, v34
    v_add_u32 v10, 2050, v34
    v_add_u32 v11, 3074, v34
    v_add_u32 v7, s7, v1
    v_mov_b32 v13, 128
    v_and_b32 v34, 13, v2
    v_and_b32 v35, 1, v3
    v_lshl_add_u32 v34, v35, 1, v34
    v_and_b32 v35, 2, v3
    v_lshl_add_u32 v34, v35, 3, v34
    v_lshlrev_b32 v35, 4, v33
    v_xor_b32 v35, s8, v35
    v_lshl_add_u32 v34, v34, 6, v35
    v_and_b32 v35, 2, v2
    v_lshl_add_u32 v34, v35, 2, v34
    v_add_u32 v12, 118784, v34
    s_and_b32 s66, s65, 1
    s_lshl_b32 s66, s66, 12
    v_add_u32 v18, s66, v1
    v_lshl_add_u32 v33, v3, 2, v33
    v_lshlrev_b32 v32, 3, v32
    v_lshl_add_u32 v32, v33, 8, v32
    v_add_u32 v32, 49152, v32
    s_lshl_b32 s66, s63, 2
    s_and_b32 s67, s65, 2
    s_add_u32 s66, s66, s67
    v_and_b32 v33, 7, v33
    v_xor_b32 v33, s66, v33
    v_lshl_add_u32 v19, v33, 5, v32
    v_xor_b32 v20, 32, v19
    v_xor_b32 v21, 128, v19
    v_xor_b32 v22, 160, v19
HS0:
    s_cbranch_execz L_Sret
    s_lshl_b32 s66, s65, 15
    s_lshl_b32 s67, s64, 8
    s_add_u32 s66, s66, s67
    v_lshlrev_b32 v32, 1, v3
    v_xor_b32 v32, v32, v2
    v_lshl_add_u32 v32, v32, 4, s66
    v_lshl_add_u32 v24, v3, 11, v32
    v_xor_b32 v32, 128, v24
    v_add_u32 v25, 7168, v32
    v_add_u32 v26, 14336, v24
    v_add_u32 v27, 21504, v32
    s_bfe_u32 s17, s101, 0x20002
    s_lshl_b32 s12, s61, 4
    s_add_u32 s12, s12, s62
    s_lshl_b32 s12, s12, 14
    s_add_u32 s12, s12, s3
    v_lshrrev_b32 v218, 5, v0
    v_lshl_add_u32 v218, v218, 3, s8
    v_add_u32 v218, 114896, v218
    s_lshl_b32 s66, s64, 2
    s_cmp_eq_u32 s64, 7
    s_cselect_b32 s66, 0, s66
    s_mul_i32 s67, s63, 28
    s_add_u32 s66, s66, s67
    s_lshl_b32 s22, s66, 17
    s_add_u32 s23, s22, 262144
    s_add_u32 s4, s22, 131072
    s_add_u32 s13, s66, s17
    s_lshl_b32 s13, s13, 17
    s_lshl_b32 s66, s65, 15
    s_lshl_b32 s67, s64, 8
    s_add_u32 s66, s66, s67
    v_lshrrev_b32 v37, 1, v0
    v_lshl_add_u32 v37, v37, 11, s66
    v_and_b32 v38, 1, v0
    v_lshl_add_u32 v37, v38, 7, v37
    v_subrev_u32 v6, 0, v4
    v_lshrrev_b32 v17, 4, v6
    v_and_b32 v17, 48, v17
    v_xor_b32 v17, s8, v17
    v_or_b32 v6, v17, v6
    v_subrev_u32 v5, 256, v4
    v_lshrrev_b32 v17, 4, v5
    v_and_b32 v17, 48, v17
    v_xor_b32 v17, s8, v17
    v_or_b32 v5, v17, v5
    v_mov_b32 v60, 0
    v_mov_b32 v61, 0
    v_mov_b32 v62, 0
    v_mov_b32 v63, 0
    s_lshl_b32 s66, s65, 9
    s_add_u32 s66, s66, 116736
    v_add_u32 v14, s66, v1
    v_writelane_b32 v14, s7, 32
    s_add_u32 s66, s7, 16
    v_writelane_b32 v14, s66, 33
    s_add_u32 s66, s7, 48960
    v_writelane_b32 v14, s66, 34
    s_add_u32 s66, s7, 48976
    v_writelane_b32 v14, s66, 35
    s_mov_b32 s66, 114880
    v_writelane_b32 v14, s66, 36
    s_cmp_eq_u32 s64, 7
    s_cbranch_scc1 L_csret
    s_mov_b32 m0, s11
    s_nop 0
    buffer_load_dwordx4 v252, s[36:39], s31 offen offset:0 lds
    buffer_load_dwordx4 v253, s[36:39], s31 offen offset:1024 lds
    buffer_load_dwordx4 v254, s[36:39], s31 offen offset:2048 lds
    buffer_load_dwordx4 v255, s[36:39], s31 offen offset:3072 lds
    s_waitcnt vmcnt(4)
    s_barrier
    s_mov_b32 s70, 286331153
    s_mov_b32 s71, 286331153
    s_call_b64 s[0:1], L_g1i
    s_waitcnt vmcnt(12)
    s_barrier
    s_mov_b32 s70, 841101858
    s_mov_b32 s71, 841101858
    s_call_b64 s[0:1], L_g1i
    s_call_b64 s[0:1], L_dg
    s_waitcnt vmcnt(12)
    s_barrier
    s_mov_b32 s70, 590619444
    s_mov_b32 s71, 590619444
    s_call_b64 s[0:1], L_g1i
    s_lshl_b32 s66, s61, 2
    s_add_u32 s66, s66, s65
    s_lshl_b32 s66, s66, 3
    s_add_u32 s66, s66, s64
    s_lshl_b32 s66, s66, 8
    s_mul_i32 s25, s63, 3670016
    s_add_u32 s25, s25, s66
    s_lshl_b32 s66, s64, 2
    s_add_u32 s66, s66, 14
    v_lshrrev_b32 v35, 1, v0
    v_add_u32 v35, s66, v35
    v_subrev_u32 v34, 28, v35
    v_min_u32 v35, v35, v34
    v_lshlrev_b32 v35, 10, v35
    v_and_or_b32 v35, v0, 1, v35
    v_lshlrev_b32 v35, 7, v35
    s_mov_b32 exec_lo, 1023
    s_mov_b32 exec_hi, 0
    buffer_load_dword v36, v35, s[48:51], s25 offen
    s_mov_b64 exec, -1
    s_waitcnt vmcnt(13)
    s_barrier
    s_mov_b32 s70, 1146307667
    s_mov_b32 s71, 1146307667
    s_call_b64 s[0:1], L_g1i
    s_mov_b32 exec_lo, 1047552
    s_mov_b32 exec_hi, 0
    buffer_load_dword v36, v35, s[48:51], s25 offen
    s_mov_b64 exec, -1
    s_waitcnt vmcnt(14)
    s_barrier
    s_mov_b32 s70, 1447384645
    s_mov_b32 s71, 1447384645
    s_call_b64 s[0:1], L_g1i
    s_mov_b32 exec_lo, 267386880
    s_mov_b32 exec_hi, 0
    buffer_load_dword v36, v35, s[48:51], s25 offen
    s_mov_b64 exec, -1
    s_waitcnt vmcnt(14)
    s_barrier
    s_mov_b32 s70, 1969648998
    s_mov_b32 s71, 1969648998
    s_call_b64 s[0:1], L_g1i
    s_cmp_lg_u32 s17, 1
    s_cbranch_scc1 L_only1
    buffer_load_dwordx4 v[64:67], v1, s[44:47], s6 offen offset:0 nt
    buffer_load_dwordx4 v[68:71], v1, s[44:47], s6 offen offset:1024 nt
    buffer_load_dwordx4 v[72:75], v1, s[44:47], s6 offen offset:2048 nt
    buffer_load_dwordx4 v[76:79], v1, s[44:47], s6 offen offset:3072 nt
L_only1:
    s_waitcnt vmcnt(13)
    s_barrier
    s_mov_b32 s70, 1735944056
    s_mov_b32 s71, 1735944056
    s_call_b64 s[0:1], L_g1i
    s_cmp_lg_u32 s17, 2
    s_cbranch_scc1 L_only2
    buffer_load_dwordx4 v[64:67], v1, s[44:47], s6 offen offset:0 nt
    buffer_load_dwordx4 v[68:71], v1, s[44:47], s6 offen offset:1024 nt
    buffer_load_dwordx4 v[72:75], v1, s[44:47], s6 offen offset:2048 nt
    buffer_load_dwordx4 v[76:79], v1, s[44:47], s6 offen offset:3072 nt
L_only2:
    s_waitcnt vmcnt(12)
    s_barrier
    s_mov_b32 s70, 2291632279
    s_mov_b32 s71, 2291645079
    s_call_b64 s[0:1], L_g1i
    s_cmp_lg_u32 s17, 3
    s_cbranch_scc1 L_only3
    buffer_load_dwordx4 v[64:67], v1, s[44:47], s6 offen offset:0 nt
    buffer_load_dwordx4 v[68:71], v1, s[44:47], s6 offen offset:1024 nt
    buffer_load_dwordx4 v[72:75], v1, s[44:47], s6 offen offset:2048 nt
    buffer_load_dwordx4 v[76:79], v1, s[44:47], s6 offen offset:3072 nt
L_only3:
    s_waitcnt vmcnt(12)
    s_barrier
    s_mov_b32 s70, 2592709257
    s_mov_b32 s71, 2592901257
    s_call_b64 s[0:1], L_g1i
    s_cmp_lg_u32 s17, 0
    s_cbranch_scc1 L_only4
    buffer_load_dwordx4 v[64:67], v1, s[44:47], s6 offen offset:0 nt
    buffer_load_dwordx4 v[68:71], v1, s[44:47], s6 offen offset:1024 nt
    buffer_load_dwordx4 v[72:75], v1, s[44:47], s6 offen offset:2048 nt
    buffer_load_dwordx4 v[76:79], v1, s[44:47], s6 offen offset:3072 nt
L_only4:
    s_waitcnt vmcnt(12)
    s_barrier
    s_mov_b32 s70, 3114973610
    s_mov_b32 s71, 3118045610
    s_call_b64 s[0:1], L_g1i
    s_waitcnt vmcnt(12)
    s_barrier
    s_mov_b32 s70, 2881268668
    s_mov_b32 s71, 2930420668
    s_call_b64 s[0:1], L_g1i
    s_waitcnt vmcnt(12)
    s_barrier
    s_mov_b32 s70, 3436956891
    s_mov_b32 s71, 4223388891
    s_call_b64 s[0:1], L_g1i
    s_call_b64 s[0:1], L_ho
    s_waitcnt vmcnt(12)
    s_barrier
    s_mov_b32 s70, 3738033869
    s_mov_b32 s71, 3436043981
    s_call_b64 s[0:1], L_g1i
    s_call_b64 s[0:1], L_ho2
    s_waitcnt vmcnt(12)
    s_barrier
    s_mov_b32 s70, 4260298222
    s_mov_b32 s71, 3723427310
    s_call_b64 s[0:1], L_g1i
    s_call_b64 s[0:1], L_hw
    buffer_load_dwordx4 v[208:211], v1, s[52:55], 0 offen offset:0
    buffer_load_dwordx4 v[212:215], v1, s[52:55], 0 offen offset:1024
    s_waitcnt vmcnt(14)
    s_barrier
    s_cmp_lg_u32 s65, 0
    s_cbranch_scc1 L_only5
    v_mov_b32 v33, 0
    buffer_load_dword v33, v13, s[56:59], 0 offen sc1
L_only5:
    s_mov_b32 s70, 4026527743
    s_mov_b32 s71, 4026527743
    s_call_b64 s[0:1], L_g1i
    s_call_b64 s[0:1], L_hw2
    s_branch L_Btail
HS1:
    s_cbranch_execz L_Sret
L_g1i:
    s_add_u32 m0, s3, s9
    s_lshr_b64 s[70:71], s[70:71], s101
    s_and_b32 s31, s70, 15
    s_lshl_b32 s30, s31, 7
    s_mul_i32 s31, s31, 458752
    buffer_load_dwordx4 v244, s[32:35], s30 offen offset:0 lds
    buffer_load_dwordx4 v245, s[32:35], s30 offen offset:1024 lds
    buffer_load_dwordx4 v246, s[32:35], s30 offen offset:2048 lds
    buffer_load_dwordx4 v247, s[32:35], s30 offen offset:3072 lds
L_g1w:
    s_add_u32 m0, s10, s9
    s_nop 0
    buffer_load_dwordx4 v248, s[36:39], s31 offen offset:0 lds
    buffer_load_dwordx4 v249, s[36:39], s31 offen offset:1024 lds
    buffer_load_dwordx4 v250, s[36:39], s31 offen offset:2048 lds
    buffer_load_dwordx4 v251, s[36:39], s31 offen offset:3072 lds
    s_add_u32 m0, s11, s9
    s_nop 0
    buffer_load_dwordx4 v252, s[36:39], s31 offen offset:0 lds
    buffer_load_dwordx4 v253, s[36:39], s31 offen offset:1024 lds
    buffer_load_dwordx4 v254, s[36:39], s31 offen offset:2048 lds
    buffer_load_dwordx4 v255, s[36:39], s31 offen offset:3072 lds
    s_sub_u32 s9, s9, 49152
    s_cselect_b32 s9, 98304, s9
    s_setpc_b64 s[0:1]
HM0:
    s_cbranch_execz HM1
L_dg:
    s_waitcnt lgkmcnt(0)
    s_cmp_lt_u32 s65, 2
    s_cselect_b32 s66, s18, s19
    s_bitcmp1_b32 s65, 0
    s_cselect_b32 s67, 16, 0
    s_lshr_b32 s66, s66, s67
    s_and_b32 s66, s66, 0xffff
    v_lshl_add_u32 v32, v3, 3, v2
    v_sub_u32 v32, 15, v32
    v_and_b32 v33, 1, v32
    v_lshlrev_b32 v33, 4, v33
    v_lshlrev_b32 v33, v33, s66
    v_ashrrev_i32 v32, 1, v32
    v_cmp_eq_u32 vcc, 0, v32
    s_nop 1
    v_cndmask_b32 v28, 0, v33, vcc
    v_cmp_eq_u32 vcc, 1, v32
    s_nop 1
    v_cndmask_b32 v29, 0, v33, vcc
    v_cmp_eq_u32 vcc, 2, v32
    s_nop 1
    v_cndmask_b32 v30, 0, v33, vcc
    v_cmp_eq_u32 vcc, 3, v32
    s_nop 1
    v_cndmask_b32 v31, 0, v33, vcc
    s_setpc_b64 s[0:1]
L_ho:
    v_mov_b32 v80, 0
    v_readlane_b32 s66, v67, 63
    v_readlane_b32 s67, v71, 63
    v_readlane_b32 s68, v75, 63
    v_alignbit_b32 v85, v65, v64, 16
    v_alignbit_b32 v86, v66, v65, 16
    v_alignbit_b32 v87, v67, v66, 16
    v_alignbit_b32 v89, v69, v68, 16
    v_alignbit_b32 v90, v70, v69, 16
    v_alignbit_b32 v91, v71, v70, 16
    v_mov_b32 v81, s66
    v_alignbit_b32 v93, v73, v72, 16
    v_alignbit_b32 v94, v74, v73, 16
    v_alignbit_b32 v95, v75, v74, 16
    v_mov_b32 v82, s67
    v_alignbit_b32 v97, v77, v76, 16
    v_alignbit_b32 v98, v78, v77, 16
    v_alignbit_b32 v99, v79, v78, 16
    v_mov_b32 v83, s68
    s_setpc_b64 s[0:1]
L_ho2:
    v_mov_b32_dpp v80, v67 wave_shr:1 row_mask:0xf bank_mask:0xf
    v_mov_b32_dpp v81, v71 wave_shr:1 row_mask:0xf bank_mask:0xf
    v_mov_b32_dpp v82, v75 wave_shr:1 row_mask:0xf bank_mask:0xf
    v_mov_b32_dpp v83, v79 wave_shr:1 row_mask:0xf bank_mask:0xf
    v_alignbit_b32 v84, v64, v80, 16
    v_alignbit_b32 v88, v68, v81, 16
    v_alignbit_b32 v92, v72, v82, 16
    v_alignbit_b32 v96, v76, v83, 16
    s_setpc_b64 s[0:1]
L_hw:
    s_mov_b32 exec_lo, 0xffffffc0
    ds_write_b128 v7, v[84:87] offset:48992
    s_mov_b64 exec, -1
    ds_write_b128 v7, v[88:91] offset:50016
    s_setpc_b64 s[0:1]
L_hw2:
    ds_write_b128 v7, v[92:95] offset:51040
    ds_write_b128 v7, v[96:99] offset:52064
    s_setpc_b64 s[0:1]
HM1:
    s_cbranch_execz HM2
L_Btail:
    s_add_u32 s66, s6, 16777216
    s_add_u32 m0, s3, 118784
    s_waitcnt vmcnt(14)
    s_cmp_lg_u32 s65, 0
    s_cbranch_scc1 L_only6
    s_waitcnt vmcnt(12)
    s_mov_b32 s69, 524288
    s_branch L_fu_chk
L_fu_ld:
    s_sleep 4
L_fu_ld0:
    buffer_load_dword v33, v13, s[56:59], 0 offen sc1
    s_waitcnt vmcnt(0)
L_fu_chk:
    v_cmp_ne_u32 vcc, 0, v33
    s_sub_u32 s69, s69, 1
    s_cmp_eq_u32 s69, 0
    s_cbranch_scc1 L_fu_ok
    s_cmp_eq_u64 vcc, -1
    s_cbranch_scc0 L_fu_ld
L_fu_ok:
L_only6:
    s_barrier
    buffer_load_dwordx4 v1, s[40:43], s66 offen offset:0 sc1 lds
    buffer_load_dwordx4 v1, s[40:43], s66 offen offset:1024 sc1 lds
    buffer_load_dwordx4 v1, s[40:43], s66 offen offset:2048 sc1 lds
    buffer_load_dwordx4 v1, s[40:43], s66 offen offset:3072 sc1 lds
    s_mov_b32 exec_hi, 0
    buffer_load_dword v36, v37, s[48:51], s13 offen
    s_mov_b64 exec, -1
    s_mov_b32 exec_hi, 31
    ds_write_b128 v14, v[60:63]
    s_mov_b64 exec, 63
    ds_write_b128 v7, v[84:87] offset:48992
    s_mov_b64 exec, -1
    ds_write_b128 v7, v[64:67] offset:32
    ds_write_b128 v7, v[68:71] offset:1056
    ds_write_b128 v7, v[72:75] offset:2080
    ds_write_b128 v7, v[76:79] offset:3104
    buffer_load_dwordx4 v[192:195], v1, s[32:35], s12 offen offset:0
    buffer_load_dwordx4 v[196:199], v1, s[32:35], s12 offen offset:1024
    buffer_load_dwordx4 v[200:203], v1, s[32:35], s12 offen offset:2048
    buffer_load_dwordx4 v[204:207], v1, s[32:35], s12 offen offset:3072
    s_waitcnt vmcnt(9) lgkmcnt(0)
    s_barrier
    s_add_u32 m0, s3, 49152
    s_nop 0
    buffer_load_dwordx4 v24, s[48:51], s22 offen offset:0 lds
    buffer_load_dwordx4 v25, s[48:51], s22 offen offset:1024 lds
    buffer_load_dwordx4 v26, s[48:51], s22 offen offset:2048 lds
    buffer_load_dwordx4 v27, s[48:51], s22 offen offset:3072 lds
    s_add_u32 m0, s3, 65536
    s_nop 0
    buffer_load_dwordx4 v24, s[48:51], s23 offen offset:0 lds
    buffer_load_dwordx4 v25, s[48:51], s23 offen offset:1024 lds
    buffer_load_dwordx4 v26, s[48:51], s23 offen offset:2048 lds
    buffer_load_dwordx4 v27, s[48:51], s23 offen offset:3072 lds
    s_add_u32 m0, s3, 81920
    s_nop 0
    buffer_load_dwordx4 v24, s[48:51], s4 offen offset:0 lds
    buffer_load_dwordx4 v25, s[48:51], s4 offen offset:1024 lds
    buffer_load_dwordx4 v26, s[48:51], s4 offen offset:2048 lds
    buffer_load_dwordx4 v27, s[48:51], s4 offen offset:3072 lds
    s_mov_b32 s9, 0
    v_add_u32 v23, s9, v18
    v_add_u32 v24, s9, v19
    v_add_u32 v25, s9, v20
    v_add_u32 v26, s9, v21
    v_add_u32 v27, s9, v22
    s_waitcnt vmcnt(12)
    s_barrier
    ds_read_b128 v[96:99], v6 offset:0
    ds_read2_b32 v[64:65], v8 offset0:0 offset1:1
    ds_read2_b32 v[66:67], v8 offset0:2 offset1:3
    ds_read_b128 v[100:103], v6 offset:2048
    ds_read2_b32 v[68:69], v8 offset0:128 offset1:129
    ds_read2_b32 v[70:71], v8 offset0:130 offset1:131
    ds_read_b128 v[104:107], v6 offset:4096
    ds_read2_b32 v[72:73], v9 offset0:0 offset1:1
    ds_read2_b32 v[74:75], v9 offset0:2 offset1:3
    ds_read_b128 v[108:111], v6 offset:6144
    ds_read2_b32 v[76:77], v9 offset0:128 offset1:129
    ds_read2_b32 v[78:79], v9 offset0:130 offset1:131
    ds_read_b128 v[112:115], v6 offset:8192
    ds_read2_b32 v[80:81], v10 offset0:0 offset1:1
    ds_read2_b32 v[82:83], v10 offset0:2 offset1:3
    ds_read_b128 v[116:119], v6 offset:10240
    ds_read2_b32 v[84:85], v10 offset0:128 offset1:129
    ds_read2_b32 v[86:87], v10 offset0:130 offset1:131
    ds_read_b128 v[120:123], v6 offset:12288
    ds_read2_b32 v[88:89], v11 offset0:0 offset1:1
    ds_read2_b32 v[90:91], v11 offset0:2 offset1:3
    ds_read_b128 v[124:127], v6 offset:14336
    ds_read2_b32 v[92:93], v11 offset0:128 offset1:129
    ds_read2_b32 v[94:95], v11 offset0:130 offset1:131
HM2:
    s_cbranch_execz L_ret0
    s_cmp_eq_u32 s64, 7
    s_cselect_b32 s68, 6, 2
    s_waitcnt lgkmcnt(0)
    s_setprio 1
    v_mfma_f32_16x16x32_bf16 v[32:35], v[28:31], v[96:99], 0
    v_mfma_f32_16x16x32_bf16 v[36:39], v[28:31], v[100:103], 0
    v_mfma_f32_16x16x32_bf16 v[40:43], v[28:31], v[104:107], 0
    v_mfma_f32_16x16x32_bf16 v[44:47], v[28:31], v[108:111], 0
    v_mfma_f32_16x16x32_bf16 v[48:51], v[28:31], v[112:115], 0
    v_mfma_f32_16x16x32_bf16 v[52:55], v[28:31], v[116:119], 0
    v_mfma_f32_16x16x32_bf16 v[56:59], v[28:31], v[120:123], 0
    v_mfma_f32_16x16x32_bf16 v[60:63], v[28:31], v[124:127], 0
    v_mfma_f32_16x16x32_bf16 v[32:35], v[64:67], v[96:99], v[32:35]
    ds_read_b128 v[160:163], v5 offset:0
    v_mfma_f32_16x16x32_bf16 v[36:39], v[64:67], v[100:103], v[36:39]
    ds_read2_b32 v[128:129], v8 offset0:16 offset1:17
    v_mfma_f32_16x16x32_bf16 v[36:39], v[68:71], v[96:99], v[36:39]
    ds_read2_b32 v[130:131], v8 offset0:18 offset1:19
    v_mfma_f32_16x16x32_bf16 v[40:43], v[64:67], v[104:107], v[40:43]
    ds_read_b128 v[164:167], v5 offset:2048
    v_mfma_f32_16x16x32_bf16 v[40:43], v[68:71], v[100:103], v[40:43]
    ds_read2_b32 v[132:133], v8 offset0:144 offset1:145
    v_mfma_f32_16x16x32_bf16 v[40:43], v[72:75], v[96:99], v[40:43]
    ds_read2_b32 v[134:135], v8 offset0:146 offset1:147
    v_mfma_f32_16x16x32_bf16 v[44:47], v[64:67], v[108:111], v[44:47]
    ds_read_b128 v[168:171], v5 offset:4096
    v_mfma_f32_16x16x32_bf16 v[44:47], v[68:71], v[104:107], v[44:47]
    ds_read2_b32 v[136:137], v9 offset0:16 offset1:17
    v_mfma_f32_16x16x32_bf16 v[44:47], v[72:75], v[100:103], v[44:47]
    ds_read2_b32 v[138:139], v9 offset0:18 offset1:19
    v_mfma_f32_16x16x32_bf16 v[44:47], v[76:79], v[96:99], v[44:47]
    ds_read_b128 v[172:175], v5 offset:6144
    v_mfma_f32_16x16x32_bf16 v[48:51], v[64:67], v[112:115], v[48:51]
    ds_read2_b32 v[140:141], v9 offset0:144 offset1:145
    v_mfma_f32_16x16x32_bf16 v[48:51], v[68:71], v[108:111], v[48:51]
    ds_read2_b32 v[142:143], v9 offset0:146 offset1:147
    v_mfma_f32_16x16x32_bf16 v[48:51], v[72:75], v[104:107], v[48:51]
    ds_read_b128 v[176:179], v5 offset:8192
    v_mfma_f32_16x16x32_bf16 v[48:51], v[76:79], v[100:103], v[48:51]
    ds_read2_b32 v[144:145], v10 offset0:16 offset1:17
    v_mfma_f32_16x16x32_bf16 v[48:51], v[80:83], v[96:99], v[48:51]
    ds_read2_b32 v[146:147], v10 offset0:18 offset1:19
    v_mfma_f32_16x16x32_bf16 v[52:55], v[64:67], v[116:119], v[52:55]
    ds_read_b128 v[180:183], v5 offset:10240
    v_mfma_f32_16x16x32_bf16 v[52:55], v[68:71], v[112:115], v[52:55]
    ds_read2_b32 v[148:149], v10 offset0:144 offset1:145
    v_mfma_f32_16x16x32_bf16 v[52:55], v[72:75], v[108:111], v[52:55]
    ds_read2_b32 v[150:151], v10 offset0:146 offset1:147
    v_mfma_f32_16x16x32_bf16 v[52:55], v[76:79], v[104:107], v[52:55]
    ds_read_b128 v[184:187], v5 offset:12288
    v_mfma_f32_16x16x32_bf16 v[52:55], v[80:83], v[100:103], v[52:55]
    ds_read2_b32 v[152:153], v11 offset0:16 offset1:17
    v_mfma_f32_16x16x32_bf16 v[52:55], v[84:87], v[96:99], v[52:55]
    ds_read2_b32 v[154:155], v11 offset0:18 offset1:19
    v_mfma_f32_16x16x32_bf16 v[56:59], v[64:67], v[120:123], v[56:59]
    ds_read_b128 v[188:191], v5 offset:14336
    v_mfma_f32_16x16x32_bf16 v[56:59], v[68:71], v[116:119], v[56:59]
    ds_read2_b32 v[156:157], v11 offset0:144 offset1:145
    v_mfma_f32_16x16x32_bf16 v[56:59], v[72:75], v[112:115], v[56:59]
    ds_read2_b32 v[158:159], v11 offset0:146 offset1:147
    v_mfma_f32_16x16x32_bf16 v[56:59], v[76:79], v[108:111], v[56:59]
    v_subrev_u32 v6, 512, v4
    v_lshrrev_b32 v17, 4, v6
    v_mfma_f32_16x16x32_bf16 v[56:59], v[80:83], v[104:107], v[56:59]
    v_and_b32 v17, 48, v17
    v_xor_b32 v17, s8, v17
    v_mfma_f32_16x16x32_bf16 v[56:59], v[84:87], v[100:103], v[56:59]
    v_or_b32 v6, v17, v6
    v_mfma_f32_16x16x32_bf16 v[56:59], v[88:91], v[96:99], v[56:59]
    v_mfma_f32_16x16x32_bf16 v[60:63], v[64:67], v[124:127], v[60:63]
    v_mfma_f32_16x16x32_bf16 v[60:63], v[68:71], v[120:123], v[60:63]
    v_mfma_f32_16x16x32_bf16 v[60:63], v[72:75], v[116:119], v[60:63]
    v_mfma_f32_16x16x32_bf16 v[60:63], v[76:79], v[112:115], v[60:63]
    v_mfma_f32_16x16x32_bf16 v[60:63], v[80:83], v[108:111], v[60:63]
    v_mfma_f32_16x16x32_bf16 v[60:63], v[84:87], v[104:107], v[60:63]
    v_mfma_f32_16x16x32_bf16 v[60:63], v[88:91], v[100:103], v[60:63]
    v_mfma_f32_16x16x32_bf16 v[60:63], v[92:95], v[96:99], v[60:63]
    s_call_b64 s[0:1], L_cv
    s_cmp_eq_u32 s64, 7
    s_cbranch_scc1 L_Bspare
L_cva:
HM3:
    s_cbranch_execz HM4
    s_waitcnt vmcnt(0) lgkmcnt(0)
    s_barrier
    v_mfma_f32_16x16x32_bf16 v[32:35], v[128:131], v[160:163], v[32:35]
    ds_read_b64_tr_b16 v[72:73], v26 offset:0
    v_dot2_f32_bf16 v216, v192, v208, 0
    v_mfma_f32_16x16x32_bf16 v[36:39], v[128:131], v[164:167], v[36:39]
    ds_read_b64_tr_b16 v[74:75], v26 offset:4096
    v_dot2_f32_bf16 v217, v200, v208, 0
    v_mfma_f32_16x16x32_bf16 v[36:39], v[132:135], v[160:163], v[36:39]
    ds_read_b64_tr_b16 v[88:89], v26 offset:8192
    v_dot2_f32_bf16 v216, v193, v209, v216
    v_mfma_f32_16x16x32_bf16 v[40:43], v[128:131], v[168:171], v[40:43]
    ds_read_b64_tr_b16 v[90:91], v26 offset:12288
    v_dot2_f32_bf16 v217, v201, v209, v217
    v_mfma_f32_16x16x32_bf16 v[40:43], v[132:135], v[164:167], v[40:43]
    ds_read_b128 v[96:99], v23 offset:0
    v_dot2_f32_bf16 v216, v194, v210, v216
    v_mfma_f32_16x16x32_bf16 v[40:43], v[136:139], v[160:163], v[40:43]
    ds_read_b128 v[112:115], v23 offset:8192
    v_dot2_f32_bf16 v217, v202, v210, v217
    v_mfma_f32_16x16x32_bf16 v[44:47], v[128:131], v[172:175], v[44:47]
    ds_read_b128 v[100:103], v23 offset:1024
    v_dot2_f32_bf16 v216, v195, v211, v216
    v_mfma_f32_16x16x32_bf16 v[44:47], v[132:135], v[168:171], v[44:47]
    ds_read_b128 v[116:119], v23 offset:9216
    v_dot2_f32_bf16 v217, v203, v211, v217
    v_mfma_f32_16x16x32_bf16 v[44:47], v[136:139], v[164:167], v[44:47]
    ds_read_b128 v[104:107], v23 offset:2048
    v_dot2_f32_bf16 v216, v196, v212, v216
    v_mfma_f32_16x16x32_bf16 v[44:47], v[140:143], v[160:163], v[44:47]
    ds_read_b128 v[120:123], v23 offset:10240
    v_dot2_f32_bf16 v217, v204, v212, v217
    v_mfma_f32_16x16x32_bf16 v[48:51], v[128:131], v[176:179], v[48:51]
    ds_read_b128 v[108:111], v23 offset:3072
    v_dot2_f32_bf16 v216, v197, v213, v216
    v_mfma_f32_16x16x32_bf16 v[48:51], v[132:135], v[172:175], v[48:51]
    ds_read_b128 v[124:127], v23 offset:11264
    v_dot2_f32_bf16 v217, v205, v213, v217
    v_mfma_f32_16x16x32_bf16 v[48:51], v[136:139], v[168:171], v[48:51]
    ds_read_b64_tr_b16 v[76:77], v27 offset:0
    v_dot2_f32_bf16 v216, v198, v214, v216
    v_mfma_f32_16x16x32_bf16 v[48:51], v[140:143], v[164:167], v[48:51]
    ds_read_b64_tr_b16 v[78:79], v27 offset:4096
    v_dot2_f32_bf16 v217, v206, v214, v217
    v_mfma_f32_16x16x32_bf16 v[48:51], v[144:147], v[160:163], v[48:51]
    ds_read_b64_tr_b16 v[92:93], v27 offset:8192
    v_dot2_f32_bf16 v216, v199, v215, v216
    v_mfma_f32_16x16x32_bf16 v[52:55], v[128:131], v[180:183], v[52:55]
    ds_read_b64_tr_b16 v[94:95], v27 offset:12288
    v_dot2_f32_bf16 v217, v207, v215, v217
    v_mfma_f32_16x16x32_bf16 v[52:55], v[132:135], v[176:179], v[52:55]
    ds_read_b64_tr_b16 v[64:65], v24 offset:0
    v_mfma_f32_16x16x32_bf16 v[52:55], v[136:139], v[172:175], v[52:55]
    ds_read_b64_tr_b16 v[66:67], v24 offset:4096
    v_permlane32_swap_b32 v216, v217
    v_mfma_f32_16x16x32_bf16 v[52:55], v[140:143], v[168:171], v[52:55]
    ds_read_b64_tr_b16 v[80:81], v24 offset:8192
    v_add_f32 v216, v216, v217
    v_mfma_f32_16x16x32_bf16 v[52:55], v[144:147], v[164:167], v[52:55]
    ds_read_b64_tr_b16 v[82:83], v24 offset:12288
    v_add_f32_dpp v216, v216, v216 row_shr:1 row_mask:0xf bank_mask:0xf bound_ctrl:0
    v_mfma_f32_16x16x32_bf16 v[52:55], v[148:151], v[160:163], v[52:55]
    ds_read_b64_tr_b16 v[68:69], v25 offset:0
    v_add_f32_dpp v216, v216, v216 row_shr:2 row_mask:0xf bank_mask:0xf bound_ctrl:0
    v_mfma_f32_16x16x32_bf16 v[56:59], v[128:131], v[184:187], v[56:59]
    ds_read_b64_tr_b16 v[70:71], v25 offset:4096
    v_add_f32_dpp v216, v216, v216 row_shr:4 row_mask:0xf bank_mask:0xf bound_ctrl:0
    v_mfma_f32_16x16x32_bf16 v[56:59], v[132:135], v[180:183], v[56:59]
    ds_read_b64_tr_b16 v[84:85], v25 offset:8192
    v_add_f32_dpp v216, v216, v216 row_shr:8 row_mask:0xf bank_mask:0xf bound_ctrl:0
    v_mfma_f32_16x16x32_bf16 v[56:59], v[136:139], v[176:179], v[56:59]
    ds_read_b64_tr_b16 v[86:87], v25 offset:12288
    v_add_f32_dpp v216, v216, v216 row_bcast:15 row_mask:0xa bank_mask:0xf
    v_mfma_f32_16x16x32_bf16 v[56:59], v[140:143], v[172:175], v[56:59]
    s_add_u32 s9, s9, 16384
    s_cmp_eq_u32 s9, 49152
    v_cvt_pk_bf16_f32 v216, v216, v216
    v_mfma_f32_16x16x32_bf16 v[56:59], v[144:147], v[168:171], v[56:59]
    s_cselect_b32 s9, 0, s9
    v_add_u32 v23, s9, v18
    v_lshlrev_b32 v216, 16, v216
    v_mfma_f32_16x16x32_bf16 v[56:59], v[148:151], v[164:167], v[56:59]
    v_add_u32 v24, s9, v19
    v_add_u32 v25, s9, v20
    v_mul_f32 v216, 0xbfb8aa3b, v216
    v_mfma_f32_16x16x32_bf16 v[56:59], v[152:155], v[160:163], v[56:59]
    v_add_u32 v26, s9, v21
    v_add_u32 v27, s9, v22
    v_exp_f32 v216, v216
    v_mfma_f32_16x16x32_bf16 v[60:63], v[128:131], v[188:191], v[60:63]
    v_add_f32 v216, 1.0, v216
    v_mfma_f32_16x16x32_bf16 v[60:63], v[132:135], v[184:187], v[60:63]
    v_rcp_f32 v216, v216
    v_mfma_f32_16x16x32_bf16 v[60:63], v[136:139], v[180:183], v[60:63]
    v_cvt_pk_bf16_f32 v216, v216, v216
    v_lshlrev_b32 v216, 16, v216
    v_mfma_f32_16x16x32_bf16 v[60:63], v[140:143], v[176:179], v[60:63]
    v_sub_f32 v217, 1.0, v216
    v_cvt_pk_bf16_f32 v217, v217, v217
    v_mfma_f32_16x16x32_bf16 v[60:63], v[144:147], v[172:175], v[60:63]
    v_lshlrev_b32 v217, 16, v217
    s_mov_b32 exec_lo, 0x80000000
    s_mov_b32 exec_hi, 0x80000000
    ds_write_b64 v218, v[216:217]
    s_mov_b64 exec, -1
    v_mfma_f32_16x16x32_bf16 v[60:63], v[148:151], v[168:171], v[60:63]
    v_mfma_f32_16x16x32_bf16 v[60:63], v[152:155], v[164:167], v[60:63]
    v_mfma_f32_16x16x32_bf16 v[60:63], v[156:159], v[160:163], v[60:63]
HM4:
    s_cbranch_execz HM5
    s_waitcnt lgkmcnt(0)
L_s0:
    v_mfma_f32_16x16x32_bf16 v[224:227], v[72:75], v[96:99], 0
    ds_read_b64_tr_b16 v[136:137], v26 offset:0
    v_mfma_f32_16x16x32_bf16 v[224:227], v[88:91], v[112:115], v[224:227]
    ds_read_b64_tr_b16 v[138:139], v26 offset:4096
    v_mfma_f32_16x16x32_bf16 v[228:231], v[88:91], v[116:119], 0
    ds_read_b64_tr_b16 v[152:153], v26 offset:8192
    v_mfma_f32_16x16x32_bf16 v[228:231], v[72:75], v[100:103], v[228:231]
    ds_read_b64_tr_b16 v[154:155], v26 offset:12288
    v_mfma_f32_16x16x32_bf16 v[232:235], v[72:75], v[104:107], 0
    ds_read_b128 v[160:163], v23 offset:0
    v_mfma_f32_16x16x32_bf16 v[232:235], v[88:91], v[120:123], v[232:235]
    ds_read_b128 v[176:179], v23 offset:8192
    v_mfma_f32_16x16x32_bf16 v[236:239], v[88:91], v[124:127], 0
    ds_read_b128 v[164:167], v23 offset:1024
    v_mfma_f32_16x16x32_bf16 v[236:239], v[72:75], v[108:111], v[236:239]
    ds_read_b128 v[180:183], v23 offset:9216
    v_mfma_f32_16x16x32_bf16 v[240:243], v[76:79], v[96:99], 0
    ds_read_b128 v[168:171], v23 offset:2048
    v_mfma_f32_16x16x32_bf16 v[240:243], v[92:95], v[112:115], v[240:243]
    ds_read_b128 v[184:187], v23 offset:10240
    v_mfma_f32_16x16x32_bf16 v[244:247], v[92:95], v[116:119], 0
    ds_read_b128 v[172:175], v23 offset:3072
    v_mfma_f32_16x16x32_bf16 v[244:247], v[76:79], v[100:103], v[244:247]
    ds_read_b128 v[188:191], v23 offset:11264
    v_mfma_f32_16x16x32_bf16 v[248:251], v[76:79], v[104:107], 0
    ds_read_b64_tr_b16 v[140:141], v27 offset:0
    v_mfma_f32_16x16x32_bf16 v[248:251], v[92:95], v[120:123], v[248:251]
    ds_read_b64_tr_b16 v[142:143], v27 offset:4096
    v_mfma_f32_16x16x32_bf16 v[252:255], v[92:95], v[124:127], 0
    ds_read_b64_tr_b16 v[156:157], v27 offset:8192
    v_mfma_f32_16x16x32_bf16 v[252:255], v[76:79], v[108:111], v[252:255]
    ds_read_b64_tr_b16 v[158:159], v27 offset:12288
    v_mfma_f32_16x16x32_bf16 v[192:195], v[64:67], v[96:99], 0
    ds_read_b64_tr_b16 v[128:129], v24 offset:0
    v_mfma_f32_16x16x32_bf16 v[192:195], v[80:83], v[112:115], v[192:195]
    ds_read_b64_tr_b16 v[130:131], v24 offset:4096
    v_mfma_f32_16x16x32_bf16 v[196:199], v[80:83], v[116:119], 0
    ds_read_b64_tr_b16 v[144:145], v24 offset:8192
    v_mfma_f32_16x16x32_bf16 v[196:199], v[64:67], v[100:103], v[196:199]
    ds_read_b64_tr_b16 v[146:147], v24 offset:12288
    v_mfma_f32_16x16x32_bf16 v[200:203], v[64:67], v[104:107], 0
    ds_read_b64_tr_b16 v[132:133], v25 offset:0
    v_mfma_f32_16x16x32_bf16 v[200:203], v[80:83], v[120:123], v[200:203]
    ds_read_b64_tr_b16 v[134:135], v25 offset:4096
    v_mfma_f32_16x16x32_bf16 v[204:207], v[80:83], v[124:127], 0
    ds_read_b64_tr_b16 v[148:149], v25 offset:8192
    v_mfma_f32_16x16x32_bf16 v[204:207], v[64:67], v[108:111], v[204:207]
    ds_read_b64_tr_b16 v[150:151], v25 offset:12288
    v_mfma_f32_16x16x32_bf16 v[208:211], v[68:71], v[96:99], 0
    s_add_u32 s9, s9, 16384
    s_cmp_eq_u32 s9, 49152
    v_mfma_f32_16x16x32_bf16 v[208:211], v[84:87], v[112:115], v[208:211]
    s_cselect_b32 s9, 0, s9
    v_add_u32 v23, s9, v18
    v_mfma_f32_16x16x32_bf16 v[212:215], v[84:87], v[116:119], 0
    v_add_u32 v24, s9, v19
    v_add_u32 v25, s9, v20
    v_mfma_f32_16x16x32_bf16 v[212:215], v[68:71], v[100:103], v[212:215]
    v_add_u32 v26, s9, v21
    v_add_u32 v27, s9, v22
    v_mfma_f32_16x16x32_bf16 v[216:219], v[68:71], v[104:107], 0
    s_cmp_eq_u32 s64, 7
    v_mfma_f32_16x16x32_bf16 v[216:219], v[84:87], v[120:123], v[216:219]
    v_mfma_f32_16x16x32_bf16 v[220:223], v[84:87], v[124:127], 0
    v_mfma_f32_16x16x32_bf16 v[220:223], v[68:71], v[108:111], v[220:223]
    s_cbranch_scc1 L_g2loop
HM5:
    s_cbranch_execz HM6
    s_waitcnt lgkmcnt(0)
    v_mfma_f32_16x16x32_bf16 v[224:227], v[136:139], v[160:163], v[224:227]
    ds_read_b64_tr_b16 v[72:73], v26 offset:0
    v_mfma_f32_16x16x32_bf16 v[224:227], v[152:155], v[176:179], v[224:227]
    ds_read_b64_tr_b16 v[74:75], v26 offset:4096
    v_mfma_f32_16x16x32_bf16 v[228:231], v[152:155], v[180:183], v[228:231]
    ds_read_b64_tr_b16 v[88:89], v26 offset:8192
    v_mfma_f32_16x16x32_bf16 v[228:231], v[136:139], v[164:167], v[228:231]
    ds_read_b64_tr_b16 v[90:91], v26 offset:12288
    v_mfma_f32_16x16x32_bf16 v[232:235], v[136:139], v[168:171], v[232:235]
    ds_read_b128 v[96:99], v23 offset:0
    v_mfma_f32_16x16x32_bf16 v[232:235], v[152:155], v[184:187], v[232:235]
    ds_read_b128 v[112:115], v23 offset:8192
    v_mfma_f32_16x16x32_bf16 v[236:239], v[152:155], v[188:191], v[236:239]
    ds_read_b128 v[100:103], v23 offset:1024
    v_mfma_f32_16x16x32_bf16 v[236:239], v[136:139], v[172:175], v[236:239]
    ds_read_b128 v[116:119], v23 offset:9216
    v_mfma_f32_16x16x32_bf16 v[240:243], v[140:143], v[160:163], v[240:243]
    ds_read_b128 v[104:107], v23 offset:2048
    v_mfma_f32_16x16x32_bf16 v[240:243], v[156:159], v[176:179], v[240:243]
    ds_read_b128 v[120:123], v23 offset:10240
    v_mfma_f32_16x16x32_bf16 v[244:247], v[156:159], v[180:183], v[244:247]
    ds_read_b128 v[108:111], v23 offset:3072
    v_mfma_f32_16x16x32_bf16 v[244:247], v[140:143], v[164:167], v[244:247]
    ds_read_b128 v[124:127], v23 offset:11264
    v_mfma_f32_16x16x32_bf16 v[248:251], v[140:143], v[168:171], v[248:251]
    ds_read_b64_tr_b16 v[76:77], v27 offset:0
    v_mfma_f32_16x16x32_bf16 v[248:251], v[156:159], v[184:187], v[248:251]
    ds_read_b64_tr_b16 v[78:79], v27 offset:4096
    v_mfma_f32_16x16x32_bf16 v[252:255], v[156:159], v[188:191], v[252:255]
    ds_read_b64_tr_b16 v[92:93], v27 offset:8192
    v_mfma_f32_16x16x32_bf16 v[252:255], v[140:143], v[172:175], v[252:255]
    ds_read_b64_tr_b16 v[94:95], v27 offset:12288
    v_mfma_f32_16x16x32_bf16 v[192:195], v[128:131], v[160:163], v[192:195]
    ds_read_b64_tr_b16 v[64:65], v24 offset:0
    v_mfma_f32_16x16x32_bf16 v[192:195], v[144:147], v[176:179], v[192:195]
    ds_read_b64_tr_b16 v[66:67], v24 offset:4096
    v_mfma_f32_16x16x32_bf16 v[196:199], v[144:147], v[180:183], v[196:199]
    ds_read_b64_tr_b16 v[80:81], v24 offset:8192
    v_mfma_f32_16x16x32_bf16 v[196:199], v[128:131], v[164:167], v[196:199]
    ds_read_b64_tr_b16 v[82:83], v24 offset:12288
    v_mfma_f32_16x16x32_bf16 v[200:203], v[128:131], v[168:171], v[200:203]
    ds_read_b64_tr_b16 v[68:69], v25 offset:0
    v_mfma_f32_16x16x32_bf16 v[200:203], v[144:147], v[184:187], v[200:203]
    ds_read_b64_tr_b16 v[70:71], v25 offset:4096
    v_mfma_f32_16x16x32_bf16 v[204:207], v[144:147], v[188:191], v[204:207]
    ds_read_b64_tr_b16 v[84:85], v25 offset:8192
    v_mfma_f32_16x16x32_bf16 v[204:207], v[128:131], v[172:175], v[204:207]
    ds_read_b64_tr_b16 v[86:87], v25 offset:12288
    v_mfma_f32_16x16x32_bf16 v[208:211], v[132:135], v[160:163], v[208:211]
    s_add_u32 s9, s9, 16384
    s_cmp_eq_u32 s9, 49152
    v_mfma_f32_16x16x32_bf16 v[208:211], v[148:151], v[176:179], v[208:211]
    s_cselect_b32 s9, 0, s9
    v_add_u32 v23, s9, v18
    v_mfma_f32_16x16x32_bf16 v[212:215], v[148:151], v[180:183], v[212:215]
    v_add_u32 v24, s9, v19
    v_add_u32 v25, s9, v20
    v_mfma_f32_16x16x32_bf16 v[212:215], v[132:135], v[164:167], v[212:215]
    v_add_u32 v26, s9, v21
    v_add_u32 v27, s9, v22
    v_mfma_f32_16x16x32_bf16 v[216:219], v[132:135], v[168:171], v[216:219]
    v_mfma_f32_16x16x32_bf16 v[216:219], v[148:151], v[184:187], v[216:219]
    v_mfma_f32_16x16x32_bf16 v[220:223], v[148:151], v[188:191], v[220:223]
    v_mfma_f32_16x16x32_bf16 v[220:223], v[132:135], v[172:175], v[220:223]
    s_waitcnt lgkmcnt(0)
    s_barrier
    v_mfma_f32_16x16x32_bf16 v[224:227], v[72:75], v[96:99], v[224:227]
    ds_read_b128 v[160:163], v6 offset:0
    v_mfma_f32_16x16x32_bf16 v[224:227], v[88:91], v[112:115], v[224:227]
    ds_read2_b32 v[128:129], v8 offset0:32 offset1:33
    v_mfma_f32_16x16x32_bf16 v[228:231], v[88:91], v[116:119], v[228:231]
    ds_read2_b32 v[130:131], v8 offset0:34 offset1:35
    v_mfma_f32_16x16x32_bf16 v[228:231], v[72:75], v[100:103], v[228:231]
    ds_read_b128 v[164:167], v6 offset:2048
    v_mfma_f32_16x16x32_bf16 v[232:235], v[72:75], v[104:107], v[232:235]
    ds_read2_b32 v[132:133], v8 offset0:160 offset1:161
    v_mfma_f32_16x16x32_bf16 v[232:235], v[88:91], v[120:123], v[232:235]
    ds_read2_b32 v[134:135], v8 offset0:162 offset1:163
    v_mfma_f32_16x16x32_bf16 v[236:239], v[88:91], v[124:127], v[236:239]
    ds_read_b128 v[168:171], v6 offset:4096
    v_mfma_f32_16x16x32_bf16 v[236:239], v[72:75], v[108:111], v[236:239]
    ds_read2_b32 v[136:137], v9 offset0:32 offset1:33
    v_mfma_f32_16x16x32_bf16 v[240:243], v[76:79], v[96:99], v[240:243]
    ds_read2_b32 v[138:139], v9 offset0:34 offset1:35
    v_mfma_f32_16x16x32_bf16 v[240:243], v[92:95], v[112:115], v[240:243]
    ds_read_b128 v[172:175], v6 offset:6144
    v_mfma_f32_16x16x32_bf16 v[244:247], v[92:95], v[116:119], v[244:247]
    ds_read2_b32 v[140:141], v9 offset0:160 offset1:161
    v_mfma_f32_16x16x32_bf16 v[244:247], v[76:79], v[100:103], v[244:247]
    ds_read2_b32 v[142:143], v9 offset0:162 offset1:163
    v_mfma_f32_16x16x32_bf16 v[248:251], v[76:79], v[104:107], v[248:251]
    ds_read_b128 v[176:179], v6 offset:8192
    v_mfma_f32_16x16x32_bf16 v[248:251], v[92:95], v[120:123], v[248:251]
    ds_read2_b32 v[144:145], v10 offset0:32 offset1:33
    v_mfma_f32_16x16x32_bf16 v[252:255], v[92:95], v[124:127], v[252:255]
    ds_read2_b32 v[146:147], v10 offset0:34 offset1:35
    v_mfma_f32_16x16x32_bf16 v[252:255], v[76:79], v[108:111], v[252:255]
    ds_read_b128 v[180:183], v6 offset:10240
    v_mfma_f32_16x16x32_bf16 v[192:195], v[64:67], v[96:99], v[192:195]
    ds_read2_b32 v[148:149], v10 offset0:160 offset1:161
    v_mfma_f32_16x16x32_bf16 v[192:195], v[80:83], v[112:115], v[192:195]
    ds_read2_b32 v[150:151], v10 offset0:162 offset1:163
    v_mfma_f32_16x16x32_bf16 v[196:199], v[80:83], v[116:119], v[196:199]
    ds_read_b128 v[184:187], v6 offset:12288
    v_mfma_f32_16x16x32_bf16 v[196:199], v[64:67], v[100:103], v[196:199]
    ds_read2_b32 v[152:153], v11 offset0:32 offset1:33
    v_mfma_f32_16x16x32_bf16 v[200:203], v[64:67], v[104:107], v[200:203]
    ds_read2_b32 v[154:155], v11 offset0:34 offset1:35
    v_mfma_f32_16x16x32_bf16 v[200:203], v[80:83], v[120:123], v[200:203]
    ds_read_b128 v[188:191], v6 offset:14336
    v_mfma_f32_16x16x32_bf16 v[204:207], v[80:83], v[124:127], v[204:207]
    ds_read2_b32 v[156:157], v11 offset0:160 offset1:161
    v_mfma_f32_16x16x32_bf16 v[204:207], v[64:67], v[108:111], v[204:207]
    ds_read2_b32 v[158:159], v11 offset0:162 offset1:163
    v_mfma_f32_16x16x32_bf16 v[208:211], v[68:71], v[96:99], v[208:211]
    v_subrev_u32 v4, 256, v4
    v_add_u32 v8, 64, v8
    v_mfma_f32_16x16x32_bf16 v[208:211], v[84:87], v[112:115], v[208:211]
    v_add_u32 v9, 64, v9
    v_add_u32 v10, 64, v10
    v_mfma_f32_16x16x32_bf16 v[212:215], v[84:87], v[116:119], v[212:215]
    v_add_u32 v11, 64, v11
    s_mov_b32 s68, 3
    v_mfma_f32_16x16x32_bf16 v[212:215], v[68:71], v[100:103], v[212:215]
    v_subrev_u32 v6, 512, v4
    v_lshrrev_b32 v17, 4, v6
    v_mfma_f32_16x16x32_bf16 v[216:219], v[68:71], v[104:107], v[216:219]
    v_and_b32 v17, 48, v17
    v_xor_b32 v17, s8, v17
    v_mfma_f32_16x16x32_bf16 v[216:219], v[84:87], v[120:123], v[216:219]
    v_or_b32 v6, v17, v6
    v_mfma_f32_16x16x32_bf16 v[220:223], v[84:87], v[124:127], v[220:223]
    v_mfma_f32_16x16x32_bf16 v[220:223], v[68:71], v[108:111], v[220:223]
    s_call_b64 s[0:1], L_cv
HM6:
    s_cbranch_execz HM7
    s_waitcnt lgkmcnt(0)
    s_barrier
    v_mfma_f32_16x16x32_bf16 v[32:35], v[64:67], v[96:99], v[32:35]
    ds_read_b64_tr_b16 v[136:137], v26 offset:0
    v_mfma_f32_16x16x32_bf16 v[36:39], v[64:67], v[100:103], v[36:39]
    ds_read_b64_tr_b16 v[138:139], v26 offset:4096
    v_mfma_f32_16x16x32_bf16 v[36:39], v[68:71], v[96:99], v[36:39]
    ds_read_b64_tr_b16 v[152:153], v26 offset:8192
    v_mfma_f32_16x16x32_bf16 v[40:43], v[64:67], v[104:107], v[40:43]
    ds_read_b64_tr_b16 v[154:155], v26 offset:12288
    v_mfma_f32_16x16x32_bf16 v[40:43], v[68:71], v[100:103], v[40:43]
    ds_read_b128 v[160:163], v23 offset:0
    v_mfma_f32_16x16x32_bf16 v[40:43], v[72:75], v[96:99], v[40:43]
    ds_read_b128 v[176:179], v23 offset:8192
    v_mfma_f32_16x16x32_bf16 v[44:47], v[64:67], v[108:111], v[44:47]
    ds_read_b128 v[164:167], v23 offset:1024
    v_mfma_f32_16x16x32_bf16 v[44:47], v[68:71], v[104:107], v[44:47]
    ds_read_b128 v[180:183], v23 offset:9216
    v_mfma_f32_16x16x32_bf16 v[44:47], v[72:75], v[100:103], v[44:47]
    v_cvt_pk_bf16_f32 v32, v32, v33
    v_cvt_pk_bf16_f32 v33, v34, v35
    ds_write_b64 v12, v[32:33] offset:0
    v_mfma_f32_16x16x32_bf16 v[44:47], v[76:79], v[96:99], v[44:47]
    ds_read_b128 v[168:171], v23 offset:2048
    v_mfma_f32_16x16x32_bf16 v[48:51], v[64:67], v[112:115], v[48:51]
    v_cvt_pk_bf16_f32 v36, v36, v37
    v_cvt_pk_bf16_f32 v37, v38, v39
    ds_write_b64 v12, v[36:37] offset:2048
    v_mfma_f32_16x16x32_bf16 v[48:51], v[68:71], v[108:111], v[48:51]
    ds_read_b128 v[184:187], v23 offset:10240
    v_mfma_f32_16x16x32_bf16 v[48:51], v[72:75], v[104:107], v[48:51]
    ds_read_b128 v[172:175], v23 offset:3072
    v_mfma_f32_16x16x32_bf16 v[48:51], v[76:79], v[100:103], v[48:51]
    v_cvt_pk_bf16_f32 v40, v40, v41
    v_cvt_pk_bf16_f32 v41, v42, v43
    ds_write_b64 v12, v[40:41] offset:4096
    v_mfma_f32_16x16x32_bf16 v[48:51], v[80:83], v[96:99], v[48:51]
    ds_read_b128 v[188:191], v23 offset:11264
    v_mfma_f32_16x16x32_bf16 v[52:55], v[64:67], v[116:119], v[52:55]
    ds_read_b64_tr_b16 v[140:141], v27 offset:0
    v_mfma_f32_16x16x32_bf16 v[52:55], v[68:71], v[112:115], v[52:55]
    ds_read_b64_tr_b16 v[142:143], v27 offset:4096
    v_mfma_f32_16x16x32_bf16 v[52:55], v[72:75], v[108:111], v[52:55]
    v_cvt_pk_bf16_f32 v44, v44, v45
    v_cvt_pk_bf16_f32 v45, v46, v47
    ds_write_b64 v12, v[44:45] offset:6144
    v_mfma_f32_16x16x32_bf16 v[52:55], v[76:79], v[104:107], v[52:55]
    ds_read_b64_tr_b16 v[156:157], v27 offset:8192
    v_mfma_f32_16x16x32_bf16 v[52:55], v[80:83], v[100:103], v[52:55]
    ds_read_b64_tr_b16 v[158:159], v27 offset:12288
    v_mfma_f32_16x16x32_bf16 v[52:55], v[84:87], v[96:99], v[52:55]
    ds_read_b64_tr_b16 v[128:129], v24 offset:0
    v_mfma_f32_16x16x32_bf16 v[56:59], v[64:67], v[120:123], v[56:59]
    ds_read_b64_tr_b16 v[130:131], v24 offset:4096
    v_mfma_f32_16x16x32_bf16 v[56:59], v[68:71], v[116:119], v[56:59]
    v_cvt_pk_bf16_f32 v48, v48, v49
    v_cvt_pk_bf16_f32 v49, v50, v51
    ds_write_b64 v12, v[48:49] offset:8192
    v_mfma_f32_16x16x32_bf16 v[56:59], v[72:75], v[112:115], v[56:59]
    ds_read_b64_tr_b16 v[144:145], v24 offset:8192
    v_mfma_f32_16x16x32_bf16 v[56:59], v[76:79], v[108:111], v[56:59]
    ds_read_b64_tr_b16 v[146:147], v24 offset:12288
    v_mfma_f32_16x16x32_bf16 v[56:59], v[80:83], v[104:107], v[56:59]
    ds_read_b64_tr_b16 v[132:133], v25 offset:0
    v_mfma_f32_16x16x32_bf16 v[56:59], v[84:87], v[100:103], v[56:59]
    ds_read_b64_tr_b16 v[134:135], v25 offset:4096
    v_mfma_f32_16x16x32_bf16 v[56:59], v[88:91], v[96:99], v[56:59]
    ds_read_b64_tr_b16 v[148:149], v25 offset:8192
    v_mfma_f32_16x16x32_bf16 v[60:63], v[64:67], v[124:127], v[60:63]
    v_cvt_pk_bf16_f32 v52, v52, v53
    v_cvt_pk_bf16_f32 v53, v54, v55
    ds_write_b64 v12, v[52:53] offset:10240
    v_mfma_f32_16x16x32_bf16 v[60:63], v[68:71], v[120:123], v[60:63]
    ds_read_b64_tr_b16 v[150:151], v25 offset:12288
    v_mfma_f32_16x16x32_bf16 v[60:63], v[72:75], v[116:119], v[60:63]
    s_add_u32 s9, s9, 16384
    s_cmp_eq_u32 s9, 49152
    v_mfma_f32_16x16x32_bf16 v[60:63], v[76:79], v[112:115], v[60:63]
    s_cselect_b32 s9, 0, s9
    v_add_u32 v23, s9, v18
    v_mfma_f32_16x16x32_bf16 v[60:63], v[80:83], v[108:111], v[60:63]
    v_add_u32 v24, s9, v19
    v_add_u32 v25, s9, v20
    v_mfma_f32_16x16x32_bf16 v[60:63], v[84:87], v[104:107], v[60:63]
    v_add_u32 v26, s9, v21
    v_add_u32 v27, s9, v22
    v_mfma_f32_16x16x32_bf16 v[60:63], v[88:91], v[100:103], v[60:63]
    s_mov_b32 s68, 12
    v_mfma_f32_16x16x32_bf16 v[60:63], v[92:95], v[96:99], v[60:63]
    v_cvt_pk_bf16_f32 v56, v56, v57
    v_cvt_pk_bf16_f32 v57, v58, v59
    ds_write_b64 v12, v[56:57] offset:12288
    s_nop 4
    v_cvt_pk_bf16_f32 v60, v60, v61
    v_cvt_pk_bf16_f32 v61, v62, v63
    ds_write_b64 v12, v[60:61] offset:14336
HM7:
    s_cbranch_execz L_ret0
    .p2align 3
L_g2loop:
    s_waitcnt lgkmcnt(0)
    s_barrier
    v_mfma_f32_16x16x32_bf16 v[224:227], v[136:139], v[160:163], v[224:227]
    ds_read_b64_tr_b16 v[72:73], v26 offset:0
    v_mfma_f32_16x16x32_bf16 v[224:227], v[152:155], v[176:179], v[224:227]
    ds_read_b64_tr_b16 v[74:75], v26 offset:4096
    v_mfma_f32_16x16x32_bf16 v[228:231], v[152:155], v[180:183], v[228:231]
    ds_read_b64_tr_b16 v[88:89], v26 offset:8192
    v_mfma_f32_16x16x32_bf16 v[228:231], v[136:139], v[164:167], v[228:231]
    ds_read_b64_tr_b16 v[90:91], v26 offset:12288
    v_mfma_f32_16x16x32_bf16 v[232:235], v[136:139], v[168:171], v[232:235]
    ds_read_b128 v[96:99], v23 offset:0
    v_mfma_f32_16x16x32_bf16 v[232:235], v[152:155], v[184:187], v[232:235]
    ds_read_b128 v[112:115], v23 offset:8192
    v_mfma_f32_16x16x32_bf16 v[236:239], v[152:155], v[188:191], v[236:239]
    v_mfma_f32_16x16x32_bf16 v[236:239], v[136:139], v[172:175], v[236:239]
    ds_read_b128 v[100:103], v23 offset:1024
    v_mfma_f32_16x16x32_bf16 v[240:243], v[140:143], v[160:163], v[240:243]
    ds_read_b128 v[116:119], v23 offset:9216
    v_mfma_f32_16x16x32_bf16 v[240:243], v[156:159], v[176:179], v[240:243]
    ds_read_b128 v[104:107], v23 offset:2048
    v_mfma_f32_16x16x32_bf16 v[244:247], v[156:159], v[180:183], v[244:247]
    ds_read_b128 v[120:123], v23 offset:10240
    v_mfma_f32_16x16x32_bf16 v[244:247], v[140:143], v[164:167], v[244:247]
    ds_read_b128 v[108:111], v23 offset:3072
    v_mfma_f32_16x16x32_bf16 v[248:251], v[140:143], v[168:171], v[248:251]
    ds_read_b128 v[124:127], v23 offset:11264
    v_mfma_f32_16x16x32_bf16 v[248:251], v[156:159], v[184:187], v[248:251]
    v_mfma_f32_16x16x32_bf16 v[252:255], v[156:159], v[188:191], v[252:255]
    ds_read_b64_tr_b16 v[76:77], v27 offset:0
    v_mfma_f32_16x16x32_bf16 v[252:255], v[140:143], v[172:175], v[252:255]
    ds_read_b64_tr_b16 v[78:79], v27 offset:4096
    v_mfma_f32_16x16x32_bf16 v[192:195], v[128:131], v[160:163], v[192:195]
    ds_read_b64_tr_b16 v[92:93], v27 offset:8192
    v_mfma_f32_16x16x32_bf16 v[192:195], v[144:147], v[176:179], v[192:195]
    ds_read_b64_tr_b16 v[94:95], v27 offset:12288
    v_mfma_f32_16x16x32_bf16 v[196:199], v[144:147], v[180:183], v[196:199]
    ds_read_b64_tr_b16 v[64:65], v24 offset:0
    v_mfma_f32_16x16x32_bf16 v[196:199], v[128:131], v[164:167], v[196:199]
    ds_read_b64_tr_b16 v[66:67], v24 offset:4096
    v_mfma_f32_16x16x32_bf16 v[200:203], v[128:131], v[168:171], v[200:203]
    v_mfma_f32_16x16x32_bf16 v[200:203], v[144:147], v[184:187], v[200:203]
    ds_read_b64_tr_b16 v[80:81], v24 offset:8192
    v_mfma_f32_16x16x32_bf16 v[204:207], v[144:147], v[188:191], v[204:207]
    ds_read_b64_tr_b16 v[82:83], v24 offset:12288
    v_mfma_f32_16x16x32_bf16 v[204:207], v[128:131], v[172:175], v[204:207]
    ds_read_b64_tr_b16 v[68:69], v25 offset:0
    v_mfma_f32_16x16x32_bf16 v[208:211], v[132:135], v[160:163], v[208:211]
    ds_read_b64_tr_b16 v[70:71], v25 offset:4096
    v_mfma_f32_16x16x32_bf16 v[208:211], v[148:151], v[176:179], v[208:211]
    ds_read_b64_tr_b16 v[84:85], v25 offset:8192
    v_mfma_f32_16x16x32_bf16 v[212:215], v[148:151], v[180:183], v[212:215]
    ds_read_b64_tr_b16 v[86:87], v25 offset:12288
    v_mfma_f32_16x16x32_bf16 v[212:215], v[132:135], v[164:167], v[212:215]
    s_add_u32 s9, s9, 16384
    s_cmp_eq_u32 s9, 49152
    s_cselect_b32 s9, 0, s9
    v_add_u32 v23, s9, v18
    v_mfma_f32_16x16x32_bf16 v[216:219], v[132:135], v[168:171], v[216:219]
    v_add_u32 v24, s9, v19
    v_add_u32 v25, s9, v20
    v_mfma_f32_16x16x32_bf16 v[216:219], v[148:151], v[184:187], v[216:219]
    v_add_u32 v26, s9, v21
    v_add_u32 v27, s9, v22
    v_mfma_f32_16x16x32_bf16 v[220:223], v[148:151], v[188:191], v[220:223]
    s_sub_u32 s68, s68, 1
    s_cmp_lg_u32 s68, 0
    v_mfma_f32_16x16x32_bf16 v[220:223], v[132:135], v[172:175], v[220:223]
    s_cbranch_scc0 L_g2end
    s_waitcnt lgkmcnt(0)
    s_barrier
    v_mfma_f32_16x16x32_bf16 v[224:227], v[72:75], v[96:99], v[224:227]
    ds_read_b64_tr_b16 v[136:137], v26 offset:0
    v_mfma_f32_16x16x32_bf16 v[224:227], v[88:91], v[112:115], v[224:227]
    ds_read_b64_tr_b16 v[138:139], v26 offset:4096
    v_mfma_f32_16x16x32_bf16 v[228:231], v[88:91], v[116:119], v[228:231]
    ds_read_b64_tr_b16 v[152:153], v26 offset:8192
    v_mfma_f32_16x16x32_bf16 v[228:231], v[72:75], v[100:103], v[228:231]
    ds_read_b64_tr_b16 v[154:155], v26 offset:12288
    v_mfma_f32_16x16x32_bf16 v[232:235], v[72:75], v[104:107], v[232:235]
    ds_read_b128 v[160:163], v23 offset:0
    v_mfma_f32_16x16x32_bf16 v[232:235], v[88:91], v[120:123], v[232:235]
    ds_read_b128 v[176:179], v23 offset:8192
    v_mfma_f32_16x16x32_bf16 v[236:239], v[88:91], v[124:127], v[236:239]
    v_mfma_f32_16x16x32_bf16 v[236:239], v[72:75], v[108:111], v[236:239]
    ds_read_b128 v[164:167], v23 offset:1024
    v_mfma_f32_16x16x32_bf16 v[240:243], v[76:79], v[96:99], v[240:243]
    ds_read_b128 v[180:183], v23 offset:9216
    v_mfma_f32_16x16x32_bf16 v[240:243], v[92:95], v[112:115], v[240:243]
    ds_read_b128 v[168:171], v23 offset:2048
    v_mfma_f32_16x16x32_bf16 v[244:247], v[92:95], v[116:119], v[244:247]
    ds_read_b128 v[184:187], v23 offset:10240
    v_mfma_f32_16x16x32_bf16 v[244:247], v[76:79], v[100:103], v[244:247]
    ds_read_b128 v[172:175], v23 offset:3072
    v_mfma_f32_16x16x32_bf16 v[248:251], v[76:79], v[104:107], v[248:251]
    ds_read_b128 v[188:191], v23 offset:11264
    v_mfma_f32_16x16x32_bf16 v[248:251], v[92:95], v[120:123], v[248:251]
    v_mfma_f32_16x16x32_bf16 v[252:255], v[92:95], v[124:127], v[252:255]
    ds_read_b64_tr_b16 v[140:141], v27 offset:0
    v_mfma_f32_16x16x32_bf16 v[252:255], v[76:79], v[108:111], v[252:255]
    ds_read_b64_tr_b16 v[142:143], v27 offset:4096
    v_mfma_f32_16x16x32_bf16 v[192:195], v[64:67], v[96:99], v[192:195]
    ds_read_b64_tr_b16 v[156:157], v27 offset:8192
    v_mfma_f32_16x16x32_bf16 v[192:195], v[80:83], v[112:115], v[192:195]
    ds_read_b64_tr_b16 v[158:159], v27 offset:12288
    v_mfma_f32_16x16x32_bf16 v[196:199], v[80:83], v[116:119], v[196:199]
    ds_read_b64_tr_b16 v[128:129], v24 offset:0
    v_mfma_f32_16x16x32_bf16 v[196:199], v[64:67], v[100:103], v[196:199]
    ds_read_b64_tr_b16 v[130:131], v24 offset:4096
    v_mfma_f32_16x16x32_bf16 v[200:203], v[64:67], v[104:107], v[200:203]
    v_mfma_f32_16x16x32_bf16 v[200:203], v[80:83], v[120:123], v[200:203]
    ds_read_b64_tr_b16 v[144:145], v24 offset:8192
    v_mfma_f32_16x16x32_bf16 v[204:207], v[80:83], v[124:127], v[204:207]
    ds_read_b64_tr_b16 v[146:147], v24 offset:12288
    v_mfma_f32_16x16x32_bf16 v[204:207], v[64:67], v[108:111], v[204:207]
    ds_read_b64_tr_b16 v[132:133], v25 offset:0
    v_mfma_f32_16x16x32_bf16 v[208:211], v[68:71], v[96:99], v[208:211]
    ds_read_b64_tr_b16 v[134:135], v25 offset:4096
    v_mfma_f32_16x16x32_bf16 v[208:211], v[84:87], v[112:115], v[208:211]
    ds_read_b64_tr_b16 v[148:149], v25 offset:8192
    v_mfma_f32_16x16x32_bf16 v[212:215], v[84:87], v[116:119], v[212:215]
    ds_read_b64_tr_b16 v[150:151], v25 offset:12288
    v_mfma_f32_16x16x32_bf16 v[212:215], v[68:71], v[100:103], v[212:215]
    s_add_u32 s9, s9, 16384
    s_cmp_eq_u32 s9, 49152
    s_cselect_b32 s9, 0, s9
    v_add_u32 v23, s9, v18
    v_mfma_f32_16x16x32_bf16 v[216:219], v[68:71], v[104:107], v[216:219]
    v_add_u32 v24, s9, v19
    v_add_u32 v25, s9, v20
    v_mfma_f32_16x16x32_bf16 v[216:219], v[84:87], v[120:123], v[216:219]
    v_add_u32 v26, s9, v21
    v_add_u32 v27, s9, v22
    v_mfma_f32_16x16x32_bf16 v[220:223], v[84:87], v[124:127], v[220:223]
    v_mfma_f32_16x16x32_bf16 v[220:223], v[68:71], v[108:111], v[220:223]
    s_branch L_g2loop
L_g2end:
HM8:
    s_cbranch_execz HM9
    s_waitcnt lgkmcnt(0)
    s_barrier
    v_mfma_f32_16x16x32_bf16 v[224:227], v[72:75], v[96:99], v[224:227]
    ds_read_b64_tr_b16 v[136:137], v26 offset:0
    v_mfma_f32_16x16x32_bf16 v[224:227], v[88:91], v[112:115], v[224:227]
    ds_read_b64_tr_b16 v[138:139], v26 offset:4096
    v_mfma_f32_16x16x32_bf16 v[228:231], v[88:91], v[116:119], v[228:231]
    ds_read_b64_tr_b16 v[152:153], v26 offset:8192
    v_mfma_f32_16x16x32_bf16 v[228:231], v[72:75], v[100:103], v[228:231]
    ds_read_b64_tr_b16 v[154:155], v26 offset:12288
    v_mfma_f32_16x16x32_bf16 v[232:235], v[72:75], v[104:107], v[232:235]
    ds_read_b128 v[160:163], v23 offset:0
    v_mfma_f32_16x16x32_bf16 v[232:235], v[88:91], v[120:123], v[232:235]
    ds_read_b128 v[176:179], v23 offset:8192
    v_mfma_f32_16x16x32_bf16 v[236:239], v[88:91], v[124:127], v[236:239]
    ds_read_b128 v[164:167], v23 offset:1024
    v_mfma_f32_16x16x32_bf16 v[236:239], v[72:75], v[108:111], v[236:239]
    ds_read_b128 v[180:183], v23 offset:9216
    v_mfma_f32_16x16x32_bf16 v[240:243], v[76:79], v[96:99], v[240:243]
    ds_read_b128 v[168:171], v23 offset:2048
    v_mfma_f32_16x16x32_bf16 v[240:243], v[92:95], v[112:115], v[240:243]
    ds_read_b128 v[184:187], v23 offset:10240
    v_mfma_f32_16x16x32_bf16 v[244:247], v[92:95], v[116:119], v[244:247]
    ds_read_b128 v[172:175], v23 offset:3072
    v_mfma_f32_16x16x32_bf16 v[244:247], v[76:79], v[100:103], v[244:247]
    ds_read_b128 v[188:191], v23 offset:11264
    v_mfma_f32_16x16x32_bf16 v[248:251], v[76:79], v[104:107], v[248:251]
    ds_read_b64_tr_b16 v[140:141], v27 offset:0
    v_mfma_f32_16x16x32_bf16 v[248:251], v[92:95], v[120:123], v[248:251]
    ds_read_b64_tr_b16 v[142:143], v27 offset:4096
    v_mfma_f32_16x16x32_bf16 v[252:255], v[92:95], v[124:127], v[252:255]
    ds_read_b64_tr_b16 v[156:157], v27 offset:8192
    v_mfma_f32_16x16x32_bf16 v[252:255], v[76:79], v[108:111], v[252:255]
    ds_read_b64_tr_b16 v[158:159], v27 offset:12288
    v_mfma_f32_16x16x32_bf16 v[192:195], v[64:67], v[96:99], v[192:195]
    ds_read_b64_tr_b16 v[128:129], v24 offset:0
    v_mfma_f32_16x16x32_bf16 v[192:195], v[80:83], v[112:115], v[192:195]
    ds_read_b64_tr_b16 v[130:131], v24 offset:4096
    v_mfma_f32_16x16x32_bf16 v[196:199], v[80:83], v[116:119], v[196:199]
    ds_read_b64_tr_b16 v[144:145], v24 offset:8192
    v_mfma_f32_16x16x32_bf16 v[196:199], v[64:67], v[100:103], v[196:199]
    ds_read_b64_tr_b16 v[146:147], v24 offset:12288
    v_mfma_f32_16x16x32_bf16 v[200:203], v[64:67], v[104:107], v[200:203]
    ds_read_b64_tr_b16 v[132:133], v25 offset:0
    v_mfma_f32_16x16x32_bf16 v[200:203], v[80:83], v[120:123], v[200:203]
    ds_read_b64_tr_b16 v[134:135], v25 offset:4096
    v_mfma_f32_16x16x32_bf16 v[204:207], v[80:83], v[124:127], v[204:207]
    ds_read_b64_tr_b16 v[148:149], v25 offset:8192
    v_mfma_f32_16x16x32_bf16 v[204:207], v[64:67], v[108:111], v[204:207]
    ds_read_b64_tr_b16 v[150:151], v25 offset:12288
    s_waitcnt lgkmcnt(8)
    v_mfma_f32_16x16x32_bf16 v[224:227], v[136:139], v[160:163], v[224:227]
    v_mfma_f32_16x16x32_bf16 v[224:227], v[152:155], v[176:179], v[224:227]
    v_mfma_f32_16x16x32_bf16 v[228:231], v[152:155], v[180:183], v[228:231]
    v_mfma_f32_16x16x32_bf16 v[228:231], v[136:139], v[164:167], v[228:231]
    v_mfma_f32_16x16x32_bf16 v[232:235], v[136:139], v[168:171], v[232:235]
    v_mfma_f32_16x16x32_bf16 v[232:235], v[152:155], v[184:187], v[232:235]
    v_mfma_f32_16x16x32_bf16 v[236:239], v[152:155], v[188:191], v[236:239]
    v_mfma_f32_16x16x32_bf16 v[236:239], v[136:139], v[172:175], v[236:239]
    v_mfma_f32_16x16x32_bf16 v[240:243], v[140:143], v[160:163], v[240:243]
    v_mfma_f32_16x16x32_bf16 v[240:243], v[156:159], v[176:179], v[240:243]
    v_mfma_f32_16x16x32_bf16 v[244:247], v[156:159], v[180:183], v[244:247]
    v_mfma_f32_16x16x32_bf16 v[244:247], v[140:143], v[164:167], v[244:247]
    v_mfma_f32_16x16x32_bf16 v[248:251], v[140:143], v[168:171], v[248:251]
    v_mfma_f32_16x16x32_bf16 v[248:251], v[156:159], v[184:187], v[248:251]
    v_mfma_f32_16x16x32_bf16 v[252:255], v[156:159], v[188:191], v[252:255]
    v_mfma_f32_16x16x32_bf16 v[252:255], v[140:143], v[172:175], v[252:255]
    s_waitcnt lgkmcnt(0)
    v_mfma_f32_16x16x32_bf16 v[208:211], v[68:71], v[96:99], v[208:211]
    v_mfma_f32_16x16x32_bf16 v[208:211], v[84:87], v[112:115], v[208:211]
    v_mfma_f32_16x16x32_bf16 v[212:215], v[84:87], v[116:119], v[212:215]
    v_mfma_f32_16x16x32_bf16 v[212:215], v[68:71], v[100:103], v[212:215]
    v_cvt_pk_bf16_f32 v32, v224, v225
    v_cvt_pk_bf16_f32 v34, v240, v241
    v_mfma_f32_16x16x32_bf16 v[216:219], v[68:71], v[104:107], v[216:219]
    v_cvt_pk_bf16_f32 v33, v226, v227
    v_cvt_pk_bf16_f32 v35, v242, v243
    v_mfma_f32_16x16x32_bf16 v[216:219], v[84:87], v[120:123], v[216:219]
    v_permlane16_swap_b32 v32, v34
    s_nop 0
    v_permlane16_swap_b32 v33, v35
    buffer_store_dwordx4 v[32:35], v1, s[40:43], s5 offen offset:0 sc1
    v_mfma_f32_16x16x32_bf16 v[220:223], v[84:87], v[124:127], v[220:223]
    v_cvt_pk_bf16_f32 v36, v228, v229
    v_cvt_pk_bf16_f32 v38, v244, v245
    v_mfma_f32_16x16x32_bf16 v[220:223], v[68:71], v[108:111], v[220:223]
    v_cvt_pk_bf16_f32 v37, v230, v231
    v_cvt_pk_bf16_f32 v39, v246, v247
    v_mfma_f32_16x16x32_bf16 v[192:195], v[128:131], v[160:163], v[192:195]
    v_permlane16_swap_b32 v36, v38
    s_nop 0
    v_permlane16_swap_b32 v37, v39
    buffer_store_dwordx4 v[36:39], v1, s[40:43], s5 offen offset:1024 sc1
    v_mfma_f32_16x16x32_bf16 v[192:195], v[144:147], v[176:179], v[192:195]
    v_cvt_pk_bf16_f32 v40, v232, v233
    v_cvt_pk_bf16_f32 v42, v248, v249
    v_mfma_f32_16x16x32_bf16 v[196:199], v[144:147], v[180:183], v[196:199]
    v_cvt_pk_bf16_f32 v41, v234, v235
    v_cvt_pk_bf16_f32 v43, v250, v251
    v_mfma_f32_16x16x32_bf16 v[196:199], v[128:131], v[164:167], v[196:199]
    v_permlane16_swap_b32 v40, v42
    s_nop 0
    v_permlane16_swap_b32 v41, v43
    buffer_store_dwordx4 v[40:43], v1, s[40:43], s5 offen offset:2048 sc1
    v_mfma_f32_16x16x32_bf16 v[200:203], v[128:131], v[168:171], v[200:203]
    v_cvt_pk_bf16_f32 v44, v236, v237
    v_cvt_pk_bf16_f32 v46, v252, v253
    v_mfma_f32_16x16x32_bf16 v[200:203], v[144:147], v[184:187], v[200:203]
    v_cvt_pk_bf16_f32 v45, v238, v239
    v_cvt_pk_bf16_f32 v47, v254, v255
    v_mfma_f32_16x16x32_bf16 v[204:207], v[144:147], v[188:191], v[204:207]
    v_permlane16_swap_b32 v44, v46
    s_nop 0
    v_permlane16_swap_b32 v45, v47
    buffer_store_dwordx4 v[44:47], v1, s[40:43], s5 offen offset:3072 sc1
    v_mfma_f32_16x16x32_bf16 v[204:207], v[128:131], v[172:175], v[204:207]
    v_mfma_f32_16x16x32_bf16 v[208:211], v[132:135], v[160:163], v[208:211]
    v_mfma_f32_16x16x32_bf16 v[208:211], v[148:151], v[176:179], v[208:211]
    v_mfma_f32_16x16x32_bf16 v[212:215], v[148:151], v[180:183], v[212:215]
    v_mfma_f32_16x16x32_bf16 v[212:215], v[132:135], v[164:167], v[212:215]
    v_mfma_f32_16x16x32_bf16 v[216:219], v[132:135], v[168:171], v[216:219]
    v_mfma_f32_16x16x32_bf16 v[216:219], v[148:151], v[184:187], v[216:219]
    v_mfma_f32_16x16x32_bf16 v[220:223], v[148:151], v[188:191], v[220:223]
    v_mfma_f32_16x16x32_bf16 v[220:223], v[132:135], v[172:175], v[220:223]
    s_lshl_b32 s66, s65, 13
    s_add_u32 s66, s66, 131072
    v_add_u32 v2, s66, v1
    s_nop 4
    ds_write_b128 v2, v[192:195] offset:0
    ds_write_b128 v2, v[196:199] offset:1024
    ds_write_b128 v2, v[200:203] offset:2048
    ds_write_b128 v2, v[204:207] offset:3072
    ds_write_b128 v2, v[208:211] offset:4096
    ds_write_b128 v2, v[212:215] offset:5120
    ds_write_b128 v2, v[216:219] offset:6144
    ds_write_b128 v2, v[220:223] offset:7168
    s_waitcnt lgkmcnt(0)
    s_barrier
    s_endpgm
HM9:
    s_cbranch_execz HM11
    .p2align 3
L_cv:
    s_waitcnt lgkmcnt(0)
    v_mfma_f32_16x16x32_bf16 v[32:35], v[128:131], v[160:163], v[32:35]
    ds_read_b128 v[96:99], v6 offset:0
    v_mfma_f32_16x16x32_bf16 v[36:39], v[128:131], v[164:167], v[36:39]
    ds_read2_b32 v[64:65], v8 offset0:32 offset1:33
    v_mfma_f32_16x16x32_bf16 v[36:39], v[132:135], v[160:163], v[36:39]
    ds_read2_b32 v[66:67], v8 offset0:34 offset1:35
    v_mfma_f32_16x16x32_bf16 v[40:43], v[128:131], v[168:171], v[40:43]
    ds_read_b128 v[100:103], v6 offset:2048
    v_mfma_f32_16x16x32_bf16 v[40:43], v[132:135], v[164:167], v[40:43]
    ds_read2_b32 v[68:69], v8 offset0:160 offset1:161
    v_mfma_f32_16x16x32_bf16 v[40:43], v[136:139], v[160:163], v[40:43]
    ds_read2_b32 v[70:71], v8 offset0:162 offset1:163
    v_mfma_f32_16x16x32_bf16 v[44:47], v[128:131], v[172:175], v[44:47]
    ds_read_b128 v[104:107], v6 offset:4096
    v_mfma_f32_16x16x32_bf16 v[44:47], v[132:135], v[168:171], v[44:47]
    ds_read2_b32 v[72:73], v9 offset0:32 offset1:33
    v_mfma_f32_16x16x32_bf16 v[44:47], v[136:139], v[164:167], v[44:47]
    ds_read2_b32 v[74:75], v9 offset0:34 offset1:35
    v_mfma_f32_16x16x32_bf16 v[44:47], v[140:143], v[160:163], v[44:47]
    ds_read_b128 v[108:111], v6 offset:6144
    v_mfma_f32_16x16x32_bf16 v[48:51], v[128:131], v[176:179], v[48:51]
    ds_read2_b32 v[76:77], v9 offset0:160 offset1:161
    v_mfma_f32_16x16x32_bf16 v[48:51], v[132:135], v[172:175], v[48:51]
    ds_read2_b32 v[78:79], v9 offset0:162 offset1:163
    v_mfma_f32_16x16x32_bf16 v[48:51], v[136:139], v[168:171], v[48:51]
    ds_read_b128 v[112:115], v6 offset:8192
    v_mfma_f32_16x16x32_bf16 v[48:51], v[140:143], v[164:167], v[48:51]
    ds_read2_b32 v[80:81], v10 offset0:32 offset1:33
    v_mfma_f32_16x16x32_bf16 v[48:51], v[144:147], v[160:163], v[48:51]
    ds_read2_b32 v[82:83], v10 offset0:34 offset1:35
    v_mfma_f32_16x16x32_bf16 v[52:55], v[128:131], v[180:183], v[52:55]
    ds_read_b128 v[116:119], v6 offset:10240
    v_mfma_f32_16x16x32_bf16 v[52:55], v[132:135], v[176:179], v[52:55]
    ds_read2_b32 v[84:85], v10 offset0:160 offset1:161
    v_mfma_f32_16x16x32_bf16 v[52:55], v[136:139], v[172:175], v[52:55]
    ds_read2_b32 v[86:87], v10 offset0:162 offset1:163
    v_mfma_f32_16x16x32_bf16 v[52:55], v[140:143], v[168:171], v[52:55]
    ds_read_b128 v[120:123], v6 offset:12288
    v_mfma_f32_16x16x32_bf16 v[52:55], v[144:147], v[164:167], v[52:55]
    ds_read2_b32 v[88:89], v11 offset0:32 offset1:33
    v_mfma_f32_16x16x32_bf16 v[52:55], v[148:151], v[160:163], v[52:55]
    ds_read2_b32 v[90:91], v11 offset0:34 offset1:35
    v_mfma_f32_16x16x32_bf16 v[56:59], v[128:131], v[184:187], v[56:59]
    ds_read_b128 v[124:127], v6 offset:14336
    v_mfma_f32_16x16x32_bf16 v[56:59], v[132:135], v[180:183], v[56:59]
    ds_read2_b32 v[92:93], v11 offset0:160 offset1:161
    v_mfma_f32_16x16x32_bf16 v[56:59], v[136:139], v[176:179], v[56:59]
    ds_read2_b32 v[94:95], v11 offset0:162 offset1:163
    v_mfma_f32_16x16x32_bf16 v[56:59], v[140:143], v[172:175], v[56:59]
    v_subrev_u32 v5, 768, v4
    v_lshrrev_b32 v17, 4, v5
    v_mfma_f32_16x16x32_bf16 v[56:59], v[144:147], v[168:171], v[56:59]
    v_and_b32 v17, 48, v17
    v_xor_b32 v17, s8, v17
    v_mfma_f32_16x16x32_bf16 v[56:59], v[148:151], v[164:167], v[56:59]
    v_or_b32 v5, v17, v5
    v_mfma_f32_16x16x32_bf16 v[56:59], v[152:155], v[160:163], v[56:59]
    s_sub_u32 s68, s68, 1
    s_cmp_lg_u32 s68, 0
    v_mfma_f32_16x16x32_bf16 v[60:63], v[128:131], v[188:191], v[60:63]
    v_mfma_f32_16x16x32_bf16 v[60:63], v[132:135], v[184:187], v[60:63]
    v_mfma_f32_16x16x32_bf16 v[60:63], v[136:139], v[180:183], v[60:63]
    v_mfma_f32_16x16x32_bf16 v[60:63], v[140:143], v[176:179], v[60:63]
    v_mfma_f32_16x16x32_bf16 v[60:63], v[144:147], v[172:175], v[60:63]
    v_mfma_f32_16x16x32_bf16 v[60:63], v[148:151], v[168:171], v[60:63]
    v_mfma_f32_16x16x32_bf16 v[60:63], v[152:155], v[164:167], v[60:63]
    v_mfma_f32_16x16x32_bf16 v[60:63], v[156:159], v[160:163], v[60:63]
    s_cbranch_scc0 L_cvr
    s_waitcnt lgkmcnt(0)
    v_mfma_f32_16x16x32_bf16 v[32:35], v[64:67], v[96:99], v[32:35]
    ds_read_b128 v[160:163], v5 offset:0
    v_mfma_f32_16x16x32_bf16 v[36:39], v[64:67], v[100:103], v[36:39]
    ds_read2_b32 v[128:129], v8 offset0:48 offset1:49
    v_mfma_f32_16x16x32_bf16 v[36:39], v[68:71], v[96:99], v[36:39]
    ds_read2_b32 v[130:131], v8 offset0:50 offset1:51
    v_mfma_f32_16x16x32_bf16 v[40:43], v[64:67], v[104:107], v[40:43]
    ds_read_b128 v[164:167], v5 offset:2048
    v_mfma_f32_16x16x32_bf16 v[40:43], v[68:71], v[100:103], v[40:43]
    ds_read2_b32 v[132:133], v8 offset0:176 offset1:177
    v_mfma_f32_16x16x32_bf16 v[40:43], v[72:75], v[96:99], v[40:43]
    ds_read2_b32 v[134:135], v8 offset0:178 offset1:179
    v_mfma_f32_16x16x32_bf16 v[44:47], v[64:67], v[108:111], v[44:47]
    ds_read_b128 v[168:171], v5 offset:4096
    v_mfma_f32_16x16x32_bf16 v[44:47], v[68:71], v[104:107], v[44:47]
    ds_read2_b32 v[136:137], v9 offset0:48 offset1:49
    v_mfma_f32_16x16x32_bf16 v[44:47], v[72:75], v[100:103], v[44:47]
    ds_read2_b32 v[138:139], v9 offset0:50 offset1:51
    v_mfma_f32_16x16x32_bf16 v[44:47], v[76:79], v[96:99], v[44:47]
    ds_read_b128 v[172:175], v5 offset:6144
    v_mfma_f32_16x16x32_bf16 v[48:51], v[64:67], v[112:115], v[48:51]
    ds_read2_b32 v[140:141], v9 offset0:176 offset1:177
    v_mfma_f32_16x16x32_bf16 v[48:51], v[68:71], v[108:111], v[48:51]
    ds_read2_b32 v[142:143], v9 offset0:178 offset1:179
    v_mfma_f32_16x16x32_bf16 v[48:51], v[72:75], v[104:107], v[48:51]
    ds_read_b128 v[176:179], v5 offset:8192
    v_mfma_f32_16x16x32_bf16 v[48:51], v[76:79], v[100:103], v[48:51]
    ds_read2_b32 v[144:145], v10 offset0:48 offset1:49
    v_mfma_f32_16x16x32_bf16 v[48:51], v[80:83], v[96:99], v[48:51]
    ds_read2_b32 v[146:147], v10 offset0:50 offset1:51
    v_mfma_f32_16x16x32_bf16 v[52:55], v[64:67], v[116:119], v[52:55]
    ds_read_b128 v[180:183], v5 offset:10240
    v_mfma_f32_16x16x32_bf16 v[52:55], v[68:71], v[112:115], v[52:55]
    ds_read2_b32 v[148:149], v10 offset0:176 offset1:177
    v_mfma_f32_16x16x32_bf16 v[52:55], v[72:75], v[108:111], v[52:55]
    ds_read2_b32 v[150:151], v10 offset0:178 offset1:179
    v_mfma_f32_16x16x32_bf16 v[52:55], v[76:79], v[104:107], v[52:55]
    ds_read_b128 v[184:187], v5 offset:12288
    v_mfma_f32_16x16x32_bf16 v[52:55], v[80:83], v[100:103], v[52:55]
    ds_read2_b32 v[152:153], v11 offset0:48 offset1:49
    v_mfma_f32_16x16x32_bf16 v[52:55], v[84:87], v[96:99], v[52:55]
    ds_read2_b32 v[154:155], v11 offset0:50 offset1:51
    v_mfma_f32_16x16x32_bf16 v[56:59], v[64:67], v[120:123], v[56:59]
    ds_read_b128 v[188:191], v5 offset:14336
    v_mfma_f32_16x16x32_bf16 v[56:59], v[68:71], v[116:119], v[56:59]
    ds_read2_b32 v[156:157], v11 offset0:176 offset1:177
    v_mfma_f32_16x16x32_bf16 v[56:59], v[72:75], v[112:115], v[56:59]
    ds_read2_b32 v[158:159], v11 offset0:178 offset1:179
    v_mfma_f32_16x16x32_bf16 v[56:59], v[76:79], v[108:111], v[56:59]
    v_subrev_u32 v6, 1024, v4
    v_lshrrev_b32 v17, 4, v6
    v_mfma_f32_16x16x32_bf16 v[56:59], v[80:83], v[104:107], v[56:59]
    v_and_b32 v17, 48, v17
    v_xor_b32 v17, s8, v17
    v_mfma_f32_16x16x32_bf16 v[56:59], v[84:87], v[100:103], v[56:59]
    v_or_b32 v6, v17, v6
    v_mfma_f32_16x16x32_bf16 v[56:59], v[88:91], v[96:99], v[56:59]
    v_subrev_u32 v4, 512, v4
    v_mfma_f32_16x16x32_bf16 v[60:63], v[64:67], v[124:127], v[60:63]
    v_add_u32 v8, 128, v8
    v_mfma_f32_16x16x32_bf16 v[60:63], v[68:71], v[120:123], v[60:63]
    v_add_u32 v9, 128, v9
    v_mfma_f32_16x16x32_bf16 v[60:63], v[72:75], v[116:119], v[60:63]
    v_add_u32 v10, 128, v10
    v_mfma_f32_16x16x32_bf16 v[60:63], v[76:79], v[112:115], v[60:63]
    v_add_u32 v11, 128, v11
    v_mfma_f32_16x16x32_bf16 v[60:63], v[80:83], v[108:111], v[60:63]
    s_sub_u32 s68, s68, 1
    s_cmp_lg_u32 s68, 0
    v_mfma_f32_16x16x32_bf16 v[60:63], v[84:87], v[104:107], v[60:63]
    v_mfma_f32_16x16x32_bf16 v[60:63], v[88:91], v[100:103], v[60:63]
    v_mfma_f32_16x16x32_bf16 v[60:63], v[92:95], v[96:99], v[60:63]
    s_cbranch_scc1 L_cv
L_cvr:
    s_setpc_b64 s[0:1]
L_A0:
L_Sret:
    s_mov_b64 exec, -1
L_A1:
    s_and_b32 s30, s65, 1
    s_lshr_b32 s31, s65, 1
    v_and_b32 v2, 15, v0
    v_lshrrev_b32 v3, 4, v0
    v_lshlrev_b32 v244, 4, v0
    v_lshrrev_b32 v5, 2, v2
    v_and_b32 v6, 3, v2
    s_lshl_b32 s66, s65, 12
    s_add_u32 s66, s66, 118784
    v_and_b32 v7, 1, v6
    v_lshl_add_u32 v4, v7, 7, s66
    v_and_b32 v7, 2, v6
    v_lshl_add_u32 v4, v7, 9, v4
    v_lshrrev_b32 v7, 1, v3
    v_lshl_add_u32 v4, v7, 8, v4
    v_xor_b32 v7, v5, v7
    v_lshl_add_u32 v4, v7, 4, v4
    v_and_b32 v7, 1, v3
    v_lshl_add_u32 v250, v7, 3, v4
    v_xor_b32 v252, 32, v250
    s_lshl_b32 s66, s65, 15
    s_lshl_b32 s67, s64, 8
    s_add_u32 s66, s66, s67
    v_lshlrev_b32 v4, 1, v3
    v_xor_b32 v4, v4, v2
    v_lshl_add_u32 v4, v4, 4, s66
    v_lshl_add_u32 v245, v3, 11, v4
    v_xor_b32 v4, 128, v245
    v_add_u32 v246, 7168, v4
    v_add_u32 v247, 14336, v245
    v_add_u32 v248, 21504, v4
    s_lshl_b32 s66, s61, 4
    s_lshl_b32 s67, s63, 3
    s_add_u32 s66, s66, s67
    v_and_b32 v4, 7, v0
    v_min_u32 v4, 6, v4
    v_add_u32 v4, s66, v4
    v_lshlrev_b32 v4, 8, v4
    v_add_u32 v249, 26214400, v4
    s_waitcnt lgkmcnt(0)
    s_mov_b32 s36, s20
    s_mov_b32 s37, s21
    s_mov_b32 s38, 7340032
    s_mov_b32 s39, 0x20000
    s_mov_b32 s44, s24
    s_mov_b32 s45, s25
    s_mov_b32 s46, 4194304
    s_mov_b32 s47, 0x20000
    s_mov_b32 s40, s28
    s_mov_b32 s41, s29
    s_mov_b32 s42, 50331648
    s_mov_b32 s43, 0x20000
    s_mov_b32 s32, s4
    s_mov_b32 s33, s5
    s_mov_b32 s34, 4194304
    s_mov_b32 s35, 0x20000
    s_add_u32 s16, s66, s64
    s_lshl_b32 s16, s16, 8
    s_add_u32 s16, s16, 26214400
    s_cmp_eq_u32 s64, 7
    s_cbranch_scc1 L_Aspare
    s_setprio 1
    s_lshl_b32 s66, s30, 13
    v_lshrrev_b32 v4, 1, v2
    v_xor_b32 v4, v4, v3
    v_lshl_add_u32 v4, v4, 4, s66
    v_lshl_add_u32 v232, v2, 7, v4
    s_lshl_b32 s66, s31, 8
    s_add_u32 s66, s66, 16384
    v_lshl_add_u32 v4, v3, 3, v5
    v_lshl_add_u32 v4, v4, 9, s66
    v_lshl_add_u32 v4, v5, 5, v4
    v_and_b32 v7, 1, v3
    v_lshl_add_u32 v4, v7, 7, v4
    v_lshl_add_u32 v233, v6, 3, v4
    s_mov_b32 s3, 0
    v_add_u32 v236, s3, v233
    v_add_u32 v234, s3, v232
    v_xor_b32 v237, 32, v236
    v_xor_b32 v238, 64, v236
    v_xor_b32 v239, 96, v236
    v_xor_b32 v240, 128, v236
    v_xor_b32 v241, 160, v236
    v_xor_b32 v242, 192, v236
    v_xor_b32 v243, 224, v236
    v_xor_b32 v235, 64, v234
    s_barrier
    ds_read_b64_tr_b16 v[136:137], v236 offset:0
    ds_read_b64_tr_b16 v[138:139], v236 offset:2048
    ds_read_b128 v[168:171], v234 offset:0
    ds_read_b128 v[172:175], v234 offset:2048
    ds_read_b128 v[176:179], v234 offset:4096
    ds_read_b128 v[180:183], v234 offset:6144
    ds_read_b64_tr_b16 v[140:141], v237 offset:0
    ds_read_b64_tr_b16 v[142:143], v237 offset:2048
    ds_read_b64_tr_b16 v[144:145], v238 offset:0
    ds_read_b64_tr_b16 v[146:147], v238 offset:2048
    ds_read_b64_tr_b16 v[148:149], v239 offset:0
    ds_read_b64_tr_b16 v[150:151], v239 offset:2048
    ds_read_b64_tr_b16 v[152:153], v240 offset:0
    ds_read_b64_tr_b16 v[154:155], v240 offset:2048
    ds_read_b64_tr_b16 v[156:157], v241 offset:0
    ds_read_b64_tr_b16 v[158:159], v241 offset:2048
    ds_read_b64_tr_b16 v[160:161], v242 offset:0
    ds_read_b64_tr_b16 v[162:163], v242 offset:2048
    ds_read_b64_tr_b16 v[164:165], v243 offset:0
    ds_read_b64_tr_b16 v[166:167], v243 offset:2048
HS2:
    s_cbranch_execz L_Sret
    s_mov_b32 s68, 16
    s_waitcnt lgkmcnt(0)
    v_mfma_f32_16x16x32_bf16 v[8:11], v[136:139], v[168:171], 0
    v_mfma_f32_16x16x32_bf16 v[12:15], v[136:139], v[172:175], 0
    v_mfma_f32_16x16x32_bf16 v[16:19], v[136:139], v[176:179], 0
    v_mfma_f32_16x16x32_bf16 v[20:23], v[136:139], v[180:183], 0
    v_mfma_f32_16x16x32_bf16 v[36:39], v[140:143], v[180:183], 0
    v_mfma_f32_16x16x32_bf16 v[32:35], v[140:143], v[176:179], 0
    v_mfma_f32_16x16x32_bf16 v[28:31], v[140:143], v[172:175], 0
    v_mfma_f32_16x16x32_bf16 v[24:27], v[140:143], v[168:171], 0
    v_mfma_f32_16x16x32_bf16 v[40:43], v[144:147], v[168:171], 0
    v_mfma_f32_16x16x32_bf16 v[44:47], v[144:147], v[172:175], 0
    v_mfma_f32_16x16x32_bf16 v[48:51], v[144:147], v[176:179], 0
    v_mfma_f32_16x16x32_bf16 v[52:55], v[144:147], v[180:183], 0
    v_mfma_f32_16x16x32_bf16 v[68:71], v[148:151], v[180:183], 0
    v_mfma_f32_16x16x32_bf16 v[64:67], v[148:151], v[176:179], 0
    v_mfma_f32_16x16x32_bf16 v[60:63], v[148:151], v[172:175], 0
    v_mfma_f32_16x16x32_bf16 v[56:59], v[148:151], v[168:171], 0
    v_mfma_f32_16x16x32_bf16 v[72:75], v[152:155], v[168:171], 0
    v_mfma_f32_16x16x32_bf16 v[76:79], v[152:155], v[172:175], 0
    v_mfma_f32_16x16x32_bf16 v[80:83], v[152:155], v[176:179], 0
    v_mfma_f32_16x16x32_bf16 v[84:87], v[152:155], v[180:183], 0
    v_mfma_f32_16x16x32_bf16 v[100:103], v[156:159], v[180:183], 0
    v_mfma_f32_16x16x32_bf16 v[96:99], v[156:159], v[176:179], 0
    v_mfma_f32_16x16x32_bf16 v[92:95], v[156:159], v[172:175], 0
    v_mfma_f32_16x16x32_bf16 v[88:91], v[156:159], v[168:171], 0
    v_mfma_f32_16x16x32_bf16 v[104:107], v[160:163], v[168:171], 0
    v_mfma_f32_16x16x32_bf16 v[108:111], v[160:163], v[172:175], 0
    v_mfma_f32_16x16x32_bf16 v[112:115], v[160:163], v[176:179], 0
    v_mfma_f32_16x16x32_bf16 v[116:119], v[160:163], v[180:183], 0
    v_mfma_f32_16x16x32_bf16 v[132:135], v[164:167], v[180:183], 0
    v_mfma_f32_16x16x32_bf16 v[128:131], v[164:167], v[176:179], 0
    v_mfma_f32_16x16x32_bf16 v[124:127], v[164:167], v[172:175], 0
    v_mfma_f32_16x16x32_bf16 v[120:123], v[164:167], v[168:171], 0
    s_barrier
    ds_read_b64_tr_b16 v[184:185], v236 offset:16384
    ds_read_b64_tr_b16 v[186:187], v236 offset:18432
    ds_read_b128 v[216:219], v235 offset:0
    ds_read_b128 v[220:223], v235 offset:2048
    ds_read_b128 v[224:227], v235 offset:4096
    ds_read_b128 v[228:231], v235 offset:6144
    ds_read_b64_tr_b16 v[188:189], v237 offset:16384
    ds_read_b64_tr_b16 v[190:191], v237 offset:18432
    ds_read_b64_tr_b16 v[192:193], v238 offset:16384
    ds_read_b64_tr_b16 v[194:195], v238 offset:18432
    ds_read_b64_tr_b16 v[196:197], v239 offset:16384
    ds_read_b64_tr_b16 v[198:199], v239 offset:18432
    ds_read_b64_tr_b16 v[200:201], v240 offset:16384
    ds_read_b64_tr_b16 v[202:203], v240 offset:18432
    ds_read_b64_tr_b16 v[204:205], v241 offset:16384
    ds_read_b64_tr_b16 v[206:207], v241 offset:18432
    ds_read_b64_tr_b16 v[208:209], v242 offset:16384
    ds_read_b64_tr_b16 v[210:211], v242 offset:18432
    ds_read_b64_tr_b16 v[212:213], v243 offset:16384
    ds_read_b64_tr_b16 v[214:215], v243 offset:18432
    s_sub_u32 s3, s3, 49152
    s_cselect_b32 s3, 98304, s3
    v_add_u32 v236, s3, v233
    v_add_u32 v234, s3, v232
    v_xor_b32 v237, 32, v236
    v_xor_b32 v238, 64, v236
    v_xor_b32 v239, 96, v236
    v_xor_b32 v240, 128, v236
    v_xor_b32 v241, 160, v236
    v_xor_b32 v242, 192, v236
    v_xor_b32 v243, 224, v236
    v_xor_b32 v235, 64, v234
    s_waitcnt lgkmcnt(0)
    v_mfma_f32_16x16x32_bf16 v[8:11], v[184:187], v[216:219], v[8:11]
    v_mfma_f32_16x16x32_bf16 v[12:15], v[184:187], v[220:223], v[12:15]
    v_mfma_f32_16x16x32_bf16 v[16:19], v[184:187], v[224:227], v[16:19]
    v_mfma_f32_16x16x32_bf16 v[20:23], v[184:187], v[228:231], v[20:23]
    v_mfma_f32_16x16x32_bf16 v[36:39], v[188:191], v[228:231], v[36:39]
    v_mfma_f32_16x16x32_bf16 v[32:35], v[188:191], v[224:227], v[32:35]
    v_mfma_f32_16x16x32_bf16 v[28:31], v[188:191], v[220:223], v[28:31]
    v_mfma_f32_16x16x32_bf16 v[24:27], v[188:191], v[216:219], v[24:27]
    v_mfma_f32_16x16x32_bf16 v[40:43], v[192:195], v[216:219], v[40:43]
    v_mfma_f32_16x16x32_bf16 v[44:47], v[192:195], v[220:223], v[44:47]
    v_mfma_f32_16x16x32_bf16 v[48:51], v[192:195], v[224:227], v[48:51]
    v_mfma_f32_16x16x32_bf16 v[52:55], v[192:195], v[228:231], v[52:55]
    v_mfma_f32_16x16x32_bf16 v[68:71], v[196:199], v[228:231], v[68:71]
    v_mfma_f32_16x16x32_bf16 v[64:67], v[196:199], v[224:227], v[64:67]
    v_mfma_f32_16x16x32_bf16 v[60:63], v[196:199], v[220:223], v[60:63]
    v_mfma_f32_16x16x32_bf16 v[56:59], v[196:199], v[216:219], v[56:59]
    v_mfma_f32_16x16x32_bf16 v[72:75], v[200:203], v[216:219], v[72:75]
    v_mfma_f32_16x16x32_bf16 v[76:79], v[200:203], v[220:223], v[76:79]
    v_mfma_f32_16x16x32_bf16 v[80:83], v[200:203], v[224:227], v[80:83]
    v_mfma_f32_16x16x32_bf16 v[84:87], v[200:203], v[228:231], v[84:87]
    v_mfma_f32_16x16x32_bf16 v[100:103], v[204:207], v[228:231], v[100:103]
    v_mfma_f32_16x16x32_bf16 v[96:99], v[204:207], v[224:227], v[96:99]
    v_mfma_f32_16x16x32_bf16 v[92:95], v[204:207], v[220:223], v[92:95]
    v_mfma_f32_16x16x32_bf16 v[88:91], v[204:207], v[216:219], v[88:91]
    v_mfma_f32_16x16x32_bf16 v[104:107], v[208:211], v[216:219], v[104:107]
    v_mfma_f32_16x16x32_bf16 v[108:111], v[208:211], v[220:223], v[108:111]
    v_mfma_f32_16x16x32_bf16 v[112:115], v[208:211], v[224:227], v[112:115]
    v_mfma_f32_16x16x32_bf16 v[116:119], v[208:211], v[228:231], v[116:119]
    v_mfma_f32_16x16x32_bf16 v[132:135], v[212:215], v[228:231], v[132:135]
    v_mfma_f32_16x16x32_bf16 v[128:131], v[212:215], v[224:227], v[128:131]
    v_mfma_f32_16x16x32_bf16 v[124:127], v[212:215], v[220:223], v[124:127]
    v_mfma_f32_16x16x32_bf16 v[120:123], v[212:215], v[216:219], v[120:123]
L_go0:
    s_mov_b64 exec, 0
    s_cmp_eq_u32 s65, 0
    s_cbranch_scc1 HM10
    s_cmp_eq_u32 s65, 1
    s_cbranch_scc1 HM3
    s_cmp_eq_u32 s65, 2
    s_cbranch_scc1 HM8
    s_branch HM13
L_ret0:
    s_mov_b64 exec, -1
    s_cmp_eq_u32 s64, 7
    s_cbranch_scc1 L_Asp2
    s_barrier
    ds_read_b64_tr_b16 v[136:137], v236 offset:0
    ds_read_b64_tr_b16 v[138:139], v236 offset:2048
    ds_read_b128 v[168:171], v234 offset:0
    ds_read_b128 v[172:175], v234 offset:2048
    ds_read_b128 v[176:179], v234 offset:4096
    ds_read_b128 v[180:183], v234 offset:6144
    ds_read_b64_tr_b16 v[140:141], v237 offset:0
    ds_read_b64_tr_b16 v[142:143], v237 offset:2048
    ds_read_b64_tr_b16 v[144:145], v238 offset:0
    ds_read_b64_tr_b16 v[146:147], v238 offset:2048
    ds_read_b64_tr_b16 v[148:149], v239 offset:0
    ds_read_b64_tr_b16 v[150:151], v239 offset:2048
    ds_read_b64_tr_b16 v[152:153], v240 offset:0
    ds_read_b64_tr_b16 v[154:155], v240 offset:2048
    ds_read_b64_tr_b16 v[156:157], v241 offset:0
    ds_read_b64_tr_b16 v[158:159], v241 offset:2048
    ds_read_b64_tr_b16 v[160:161], v242 offset:0
    ds_read_b64_tr_b16 v[162:163], v242 offset:2048
    ds_read_b64_tr_b16 v[164:165], v243 offset:0
    ds_read_b64_tr_b16 v[166:167], v243 offset:2048
    s_mov_b32 s68, 15
    s_waitcnt lgkmcnt(0)
    s_branch L_g1loop
HM10:
    s_cbranch_execz HM0
    .p2align 6
L_g1loop:
    v_mfma_f32_16x16x32_bf16 v[8:11], v[136:139], v[168:171], v[8:11]
    ds_read_b64_tr_b16 v[184:185], v236 offset:16384
    v_mfma_f32_16x16x32_bf16 v[12:15], v[136:139], v[172:175], v[12:15]
    ds_read_b64_tr_b16 v[186:187], v236 offset:18432
    v_mfma_f32_16x16x32_bf16 v[16:19], v[136:139], v[176:179], v[16:19]
    ds_read_b128 v[216:219], v235 offset:0
    v_mfma_f32_16x16x32_bf16 v[20:23], v[136:139], v[180:183], v[20:23]
    ds_read_b128 v[220:223], v235 offset:2048
    v_mfma_f32_16x16x32_bf16 v[36:39], v[140:143], v[180:183], v[36:39]
    ds_read_b128 v[224:227], v235 offset:4096
    v_mfma_f32_16x16x32_bf16 v[32:35], v[140:143], v[176:179], v[32:35]
    ds_read_b128 v[228:231], v235 offset:6144
    v_mfma_f32_16x16x32_bf16 v[28:31], v[140:143], v[172:175], v[28:31]
    ds_read_b64_tr_b16 v[188:189], v237 offset:16384
    v_mfma_f32_16x16x32_bf16 v[24:27], v[140:143], v[168:171], v[24:27]
    ds_read_b64_tr_b16 v[190:191], v237 offset:18432
    v_mfma_f32_16x16x32_bf16 v[40:43], v[144:147], v[168:171], v[40:43]
    ds_read_b64_tr_b16 v[192:193], v238 offset:16384
    v_mfma_f32_16x16x32_bf16 v[44:47], v[144:147], v[172:175], v[44:47]
    ds_read_b64_tr_b16 v[194:195], v238 offset:18432
    v_mfma_f32_16x16x32_bf16 v[48:51], v[144:147], v[176:179], v[48:51]
    ds_read_b64_tr_b16 v[196:197], v239 offset:16384
    v_mfma_f32_16x16x32_bf16 v[52:55], v[144:147], v[180:183], v[52:55]
    ds_read_b64_tr_b16 v[198:199], v239 offset:18432
    v_mfma_f32_16x16x32_bf16 v[68:71], v[148:151], v[180:183], v[68:71]
    ds_read_b64_tr_b16 v[200:201], v240 offset:16384
    v_mfma_f32_16x16x32_bf16 v[64:67], v[148:151], v[176:179], v[64:67]
    ds_read_b64_tr_b16 v[202:203], v240 offset:18432
    v_mfma_f32_16x16x32_bf16 v[60:63], v[148:151], v[172:175], v[60:63]
    ds_read_b64_tr_b16 v[204:205], v241 offset:16384
    v_mfma_f32_16x16x32_bf16 v[56:59], v[148:151], v[168:171], v[56:59]
    ds_read_b64_tr_b16 v[206:207], v241 offset:18432
    v_mfma_f32_16x16x32_bf16 v[72:75], v[152:155], v[168:171], v[72:75]
    ds_read_b64_tr_b16 v[208:209], v242 offset:16384
    v_mfma_f32_16x16x32_bf16 v[76:79], v[152:155], v[172:175], v[76:79]
    ds_read_b64_tr_b16 v[210:211], v242 offset:18432
    v_mfma_f32_16x16x32_bf16 v[80:83], v[152:155], v[176:179], v[80:83]
    ds_read_b64_tr_b16 v[212:213], v243 offset:16384
    v_mfma_f32_16x16x32_bf16 v[84:87], v[152:155], v[180:183], v[84:87]
    ds_read_b64_tr_b16 v[214:215], v243 offset:18432
    v_mfma_f32_16x16x32_bf16 v[100:103], v[156:159], v[180:183], v[100:103]
    s_sub_u32 s3, s3, 49152
    s_cselect_b32 s3, 98304, s3
    v_mfma_f32_16x16x32_bf16 v[96:99], v[156:159], v[176:179], v[96:99]
    v_add_u32 v236, s3, v233
    v_mfma_f32_16x16x32_bf16 v[92:95], v[156:159], v[172:175], v[92:95]
    v_add_u32 v234, s3, v232
    v_mfma_f32_16x16x32_bf16 v[88:91], v[156:159], v[168:171], v[88:91]
    v_xor_b32 v237, 32, v236
    v_mfma_f32_16x16x32_bf16 v[104:107], v[160:163], v[168:171], v[104:107]
    v_xor_b32 v238, 64, v236
    v_mfma_f32_16x16x32_bf16 v[108:111], v[160:163], v[172:175], v[108:111]
    v_xor_b32 v239, 96, v236
    v_mfma_f32_16x16x32_bf16 v[112:115], v[160:163], v[176:179], v[112:115]
    v_xor_b32 v240, 128, v236
    v_mfma_f32_16x16x32_bf16 v[116:119], v[160:163], v[180:183], v[116:119]
    v_xor_b32 v241, 160, v236
    v_mfma_f32_16x16x32_bf16 v[132:135], v[164:167], v[180:183], v[132:135]
    v_xor_b32 v242, 192, v236
    v_mfma_f32_16x16x32_bf16 v[128:131], v[164:167], v[176:179], v[128:131]
    v_xor_b32 v243, 224, v236
    v_mfma_f32_16x16x32_bf16 v[124:127], v[164:167], v[172:175], v[124:127]
    v_xor_b32 v235, 64, v234
    v_mfma_f32_16x16x32_bf16 v[120:123], v[164:167], v[168:171], v[120:123]
L_g1mid:
    s_waitcnt lgkmcnt(0)
    s_barrier
    v_mfma_f32_16x16x32_bf16 v[8:11], v[184:187], v[216:219], v[8:11]
    ds_read_b64_tr_b16 v[136:137], v236 offset:0
    v_mfma_f32_16x16x32_bf16 v[12:15], v[184:187], v[220:223], v[12:15]
    ds_read_b64_tr_b16 v[138:139], v236 offset:2048
    v_mfma_f32_16x16x32_bf16 v[16:19], v[184:187], v[224:227], v[16:19]
    ds_read_b128 v[168:171], v234 offset:0
    v_mfma_f32_16x16x32_bf16 v[20:23], v[184:187], v[228:231], v[20:23]
    ds_read_b128 v[172:175], v234 offset:2048
    v_mfma_f32_16x16x32_bf16 v[36:39], v[188:191], v[228:231], v[36:39]
    ds_read_b128 v[176:179], v234 offset:4096
    v_mfma_f32_16x16x32_bf16 v[32:35], v[188:191], v[224:227], v[32:35]
    ds_read_b128 v[180:183], v234 offset:6144
    v_mfma_f32_16x16x32_bf16 v[28:31], v[188:191], v[220:223], v[28:31]
    ds_read_b64_tr_b16 v[140:141], v237 offset:0
    v_mfma_f32_16x16x32_bf16 v[24:27], v[188:191], v[216:219], v[24:27]
    ds_read_b64_tr_b16 v[142:143], v237 offset:2048
    v_mfma_f32_16x16x32_bf16 v[40:43], v[192:195], v[216:219], v[40:43]
    ds_read_b64_tr_b16 v[144:145], v238 offset:0
    v_mfma_f32_16x16x32_bf16 v[44:47], v[192:195], v[220:223], v[44:47]
    ds_read_b64_tr_b16 v[146:147], v238 offset:2048
    v_mfma_f32_16x16x32_bf16 v[48:51], v[192:195], v[224:227], v[48:51]
    ds_read_b64_tr_b16 v[148:149], v239 offset:0
    v_mfma_f32_16x16x32_bf16 v[52:55], v[192:195], v[228:231], v[52:55]
    ds_read_b64_tr_b16 v[150:151], v239 offset:2048
    v_mfma_f32_16x16x32_bf16 v[68:71], v[196:199], v[228:231], v[68:71]
    ds_read_b64_tr_b16 v[152:153], v240 offset:0
    v_mfma_f32_16x16x32_bf16 v[64:67], v[196:199], v[224:227], v[64:67]
    ds_read_b64_tr_b16 v[154:155], v240 offset:2048
    v_mfma_f32_16x16x32_bf16 v[60:63], v[196:199], v[220:223], v[60:63]
    ds_read_b64_tr_b16 v[156:157], v241 offset:0
    v_mfma_f32_16x16x32_bf16 v[56:59], v[196:199], v[216:219], v[56:59]
    ds_read_b64_tr_b16 v[158:159], v241 offset:2048
    v_mfma_f32_16x16x32_bf16 v[72:75], v[200:203], v[216:219], v[72:75]
    ds_read_b64_tr_b16 v[160:161], v242 offset:0
    v_mfma_f32_16x16x32_bf16 v[76:79], v[200:203], v[220:223], v[76:79]
    ds_read_b64_tr_b16 v[162:163], v242 offset:2048
    v_mfma_f32_16x16x32_bf16 v[80:83], v[200:203], v[224:227], v[80:83]
    ds_read_b64_tr_b16 v[164:165], v243 offset:0
    v_mfma_f32_16x16x32_bf16 v[84:87], v[200:203], v[228:231], v[84:87]
    ds_read_b64_tr_b16 v[166:167], v243 offset:2048
    v_mfma_f32_16x16x32_bf16 v[100:103], v[204:207], v[228:231], v[100:103]
    s_sub_u32 s68, s68, 1
    s_cmp_lg_u32 s68, 0
    v_mfma_f32_16x16x32_bf16 v[96:99], v[204:207], v[224:227], v[96:99]
    v_mfma_f32_16x16x32_bf16 v[92:95], v[204:207], v[220:223], v[92:95]
    v_mfma_f32_16x16x32_bf16 v[88:91], v[204:207], v[216:219], v[88:91]
    v_mfma_f32_16x16x32_bf16 v[104:107], v[208:211], v[216:219], v[104:107]
    v_mfma_f32_16x16x32_bf16 v[108:111], v[208:211], v[220:223], v[108:111]
    v_mfma_f32_16x16x32_bf16 v[112:115], v[208:211], v[224:227], v[112:115]
    v_mfma_f32_16x16x32_bf16 v[116:119], v[208:211], v[228:231], v[116:119]
    v_mfma_f32_16x16x32_bf16 v[132:135], v[212:215], v[228:231], v[132:135]
    v_mfma_f32_16x16x32_bf16 v[128:131], v[212:215], v[224:227], v[128:131]
    v_mfma_f32_16x16x32_bf16 v[124:127], v[212:215], v[220:223], v[124:127]
    v_mfma_f32_16x16x32_bf16 v[120:123], v[212:215], v[216:219], v[120:123]
    s_waitcnt lgkmcnt(0)
    s_cbranch_scc1 L_g1loop
HM11:
    s_cbranch_execz HM12
    s_mul_i32 s4, s61, 14
    s_add_u32 s4, s4, s62
    s_sub_u32 s4, s4, s63
    s_lshl_b32 s4, s4, 1
    s_add_u32 s4, s4, s31
    s_lshl_b32 s4, s4, 3
    s_add_u32 s4, s4, s30
    s_lshl_b32 s4, s4, 12
    s_setprio 1
    s_lshl_b32 s66, s31, 14
    s_lshl_b32 s67, s30, 12
    s_add_u32 s66, s66, s67
    v_add_u32 v232, s66, v244
    v_add_u32 v233, s67, v244
    v_cvt_pk_bf16_f32 v136, v8, v9
    v_cvt_pk_bf16_f32 v137, v10, v11
    v_cvt_pk_bf16_f32 v138, v24, v25
    v_cvt_pk_bf16_f32 v139, v26, v27
    v_pk_max_i16 v136, v136, 0
    v_pk_max_i16 v137, v137, 0
    v_pk_max_i16 v138, v138, 0
    v_pk_max_i16 v139, v139, 0
    buffer_store_dwordx4 v[136:139], v244, s[40:43], s4 offen offset:0 sc1
    ds_write_b128 v232, v[136:139] offset:0
    v_cvt_pk_bf16_f32 v140, v12, v13
    v_cvt_pk_bf16_f32 v141, v14, v15
    v_cvt_pk_bf16_f32 v142, v28, v29
    v_cvt_pk_bf16_f32 v143, v30, v31
    v_pk_max_i16 v140, v140, 0
    v_pk_max_i16 v141, v141, 0
    v_pk_max_i16 v142, v142, 0
    v_pk_max_i16 v143, v143, 0
    buffer_store_dwordx4 v[140:143], v244, s[40:43], s4 offen offset:1024 sc1
    ds_write_b128 v232, v[140:143] offset:1024
    v_cvt_pk_bf16_f32 v144, v16, v17
    v_cvt_pk_bf16_f32 v145, v18, v19
    v_cvt_pk_bf16_f32 v146, v32, v33
    v_cvt_pk_bf16_f32 v147, v34, v35
    v_pk_max_i16 v144, v144, 0
    v_pk_max_i16 v145, v145, 0
    v_pk_max_i16 v146, v146, 0
    v_pk_max_i16 v147, v147, 0
    buffer_store_dwordx4 v[144:147], v244, s[40:43], s4 offen offset:2048 sc1
    ds_write_b128 v232, v[144:147] offset:2048
    v_cvt_pk_bf16_f32 v148, v20, v21
    v_cvt_pk_bf16_f32 v149, v22, v23
    v_cvt_pk_bf16_f32 v150, v36, v37
    v_cvt_pk_bf16_f32 v151, v38, v39
    v_pk_max_i16 v148, v148, 0
    v_pk_max_i16 v149, v149, 0
    v_pk_max_i16 v150, v150, 0
    v_pk_max_i16 v151, v151, 0
    buffer_store_dwordx4 v[148:151], v244, s[40:43], s4 offen offset:3072 sc1
    ds_write_b128 v232, v[148:151] offset:3072
    s_add_u32 s4, s4, 8192
    v_cvt_pk_bf16_f32 v152, v40, v41
    v_cvt_pk_bf16_f32 v153, v42, v43
    v_cvt_pk_bf16_f32 v154, v56, v57
    v_cvt_pk_bf16_f32 v155, v58, v59
    v_pk_max_i16 v152, v152, 0
    v_pk_max_i16 v153, v153, 0
    v_pk_max_i16 v154, v154, 0
    v_pk_max_i16 v155, v155, 0
    buffer_store_dwordx4 v[152:155], v244, s[40:43], s4 offen offset:0 sc1
    ds_write_b128 v232, v[152:155] offset:8192
    v_cvt_pk_bf16_f32 v156, v44, v45
    v_cvt_pk_bf16_f32 v157, v46, v47
    v_cvt_pk_bf16_f32 v158, v60, v61
    v_cvt_pk_bf16_f32 v159, v62, v63
    v_pk_max_i16 v156, v156, 0
    v_pk_max_i16 v157, v157, 0
    v_pk_max_i16 v158, v158, 0
    v_pk_max_i16 v159, v159, 0
    buffer_store_dwordx4 v[156:159], v244, s[40:43], s4 offen offset:1024 sc1
    ds_write_b128 v232, v[156:159] offset:9216
    v_cvt_pk_bf16_f32 v160, v48, v49
    v_cvt_pk_bf16_f32 v161, v50, v51
    v_cvt_pk_bf16_f32 v162, v64, v65
    v_cvt_pk_bf16_f32 v163, v66, v67
    v_pk_max_i16 v160, v160, 0
    v_pk_max_i16 v161, v161, 0
    v_pk_max_i16 v162, v162, 0
    v_pk_max_i16 v163, v163, 0
    buffer_store_dwordx4 v[160:163], v244, s[40:43], s4 offen offset:2048 sc1
    ds_write_b128 v232, v[160:163] offset:10240
    v_cvt_pk_bf16_f32 v164, v52, v53
    v_cvt_pk_bf16_f32 v165, v54, v55
    v_cvt_pk_bf16_f32 v166, v68, v69
    v_cvt_pk_bf16_f32 v167, v70, v71
    v_pk_max_i16 v164, v164, 0
    v_pk_max_i16 v165, v165, 0
    v_pk_max_i16 v166, v166, 0
    v_pk_max_i16 v167, v167, 0
    buffer_store_dwordx4 v[164:167], v244, s[40:43], s4 offen offset:3072 sc1
    ds_write_b128 v232, v[164:167] offset:11264
    s_add_u32 s4, s4, 8192
    v_cvt_pk_bf16_f32 v136, v72, v73
    v_cvt_pk_bf16_f32 v137, v74, v75
    v_cvt_pk_bf16_f32 v138, v88, v89
    v_cvt_pk_bf16_f32 v139, v90, v91
    v_pk_max_i16 v136, v136, 0
    v_pk_max_i16 v137, v137, 0
    v_pk_max_i16 v138, v138, 0
    v_pk_max_i16 v139, v139, 0
    buffer_store_dwordx4 v[136:139], v244, s[40:43], s4 offen offset:0 sc1
    v_cvt_pk_bf16_f32 v140, v76, v77
    v_cvt_pk_bf16_f32 v141, v78, v79
    v_cvt_pk_bf16_f32 v142, v92, v93
    v_cvt_pk_bf16_f32 v143, v94, v95
    v_pk_max_i16 v140, v140, 0
    v_pk_max_i16 v141, v141, 0
    v_pk_max_i16 v142, v142, 0
    v_pk_max_i16 v143, v143, 0
    buffer_store_dwordx4 v[140:143], v244, s[40:43], s4 offen offset:1024 sc1
    v_cvt_pk_bf16_f32 v144, v80, v81
    v_cvt_pk_bf16_f32 v145, v82, v83
    v_cvt_pk_bf16_f32 v146, v96, v97
    v_cvt_pk_bf16_f32 v147, v98, v99
    v_pk_max_i16 v144, v144, 0
    v_pk_max_i16 v145, v145, 0
    v_pk_max_i16 v146, v146, 0
    v_pk_max_i16 v147, v147, 0
    buffer_store_dwordx4 v[144:147], v244, s[40:43], s4 offen offset:2048 sc1
    v_cvt_pk_bf16_f32 v148, v84, v85
    v_cvt_pk_bf16_f32 v149, v86, v87
    v_cvt_pk_bf16_f32 v150, v100, v101
    v_cvt_pk_bf16_f32 v151, v102, v103
    v_pk_max_i16 v148, v148, 0
    v_pk_max_i16 v149, v149, 0
    v_pk_max_i16 v150, v150, 0
    v_pk_max_i16 v151, v151, 0
    buffer_store_dwordx4 v[148:151], v244, s[40:43], s4 offen offset:3072 sc1
    s_add_u32 s4, s4, 8192
HM12:
    s_cbranch_execz L_ret0
    v_cvt_pk_bf16_f32 v152, v104, v105
    v_cvt_pk_bf16_f32 v153, v106, v107
    v_cvt_pk_bf16_f32 v154, v120, v121
    v_cvt_pk_bf16_f32 v155, v122, v123
    v_pk_max_i16 v152, v152, 0
    v_pk_max_i16 v153, v153, 0
    v_pk_max_i16 v154, v154, 0
    v_pk_max_i16 v155, v155, 0
    buffer_store_dwordx4 v[152:155], v244, s[40:43], s4 offen offset:0 sc1
    v_cvt_pk_bf16_f32 v156, v108, v109
    v_cvt_pk_bf16_f32 v157, v110, v111
    v_cvt_pk_bf16_f32 v158, v124, v125
    v_cvt_pk_bf16_f32 v159, v126, v127
    v_pk_max_i16 v156, v156, 0
    v_pk_max_i16 v157, v157, 0
    v_pk_max_i16 v158, v158, 0
    v_pk_max_i16 v159, v159, 0
    buffer_store_dwordx4 v[156:159], v244, s[40:43], s4 offen offset:1024 sc1
    v_cvt_pk_bf16_f32 v160, v112, v113
    v_cvt_pk_bf16_f32 v161, v114, v115
    v_cvt_pk_bf16_f32 v162, v128, v129
    v_cvt_pk_bf16_f32 v163, v130, v131
    v_pk_max_i16 v160, v160, 0
    v_pk_max_i16 v161, v161, 0
    v_pk_max_i16 v162, v162, 0
    v_pk_max_i16 v163, v163, 0
    buffer_store_dwordx4 v[160:163], v244, s[40:43], s4 offen offset:2048 sc1
    v_cvt_pk_bf16_f32 v164, v116, v117
    v_cvt_pk_bf16_f32 v165, v118, v119
    v_cvt_pk_bf16_f32 v166, v132, v133
    v_cvt_pk_bf16_f32 v167, v134, v135
    v_pk_max_i16 v164, v164, 0
    v_pk_max_i16 v165, v165, 0
    v_pk_max_i16 v166, v166, 0
    v_pk_max_i16 v167, v167, 0
    buffer_store_dwordx4 v[164:167], v244, s[40:43], s4 offen offset:3072 sc1
    s_add_u32 s4, s4, 8192
    s_cmp_lg_u32 s31, 0
    s_cbranch_scc1 L_only7
    ds_write_b128 v232, v[136:139] offset:32768
    ds_write_b128 v232, v[140:143] offset:33792
    ds_write_b128 v232, v[144:147] offset:34816
    ds_write_b128 v232, v[148:151] offset:35840
    ds_write_b128 v232, v[152:155] offset:40960
    ds_write_b128 v232, v[156:159] offset:41984
    ds_write_b128 v232, v[160:163] offset:43008
    ds_write_b128 v232, v[164:167] offset:44032
L_only7:
    s_waitcnt lgkmcnt(0)
    s_barrier
    s_setprio 0
L_hdone:
    s_mul_i32 s6, s61, 917504
    s_mul_i32 s66, s63, 458752
    s_add_u32 s6, s6, s66
    s_lshl_b32 s8, s65, 12
    s_add_u32 s6, s6, s8
    s_mul_i32 s7, s63, 3670016
    s_lshl_b32 s9, s64, 2
    s_cmp_eq_u32 s64, 7
    s_cselect_b32 s9, 0, s9
    s_mov_b32 s3, 0
    s_sub_u32 s9, s9, 1
    s_lshl_b32 s14, s60, 14
    s_add_u32 s14, s14, s8
    s_add_u32 s14, s14, 33554432
    v_mov_b32 v24, -1
    v_mov_b32 v25, -1
    v_mov_b32 v26, -1
    v_mov_b32 v27, -1
HM13:
    s_cbranch_execz HM14
    s_lshl_b32 s68, s64, 1
    s_add_u32 s68, s68, s63
    s_lshl_b32 s66, s68, 1
    s_add_u32 s66, s66, s31
    s_lshl_b32 s66, s66, 5
    v_and_b32 v4, 1, v3
    v_lshrrev_b32 v5, 1, v3
    v_lshl_add_u32 v6, v4, 4, s66
    v_lshl_add_u32 v6, v5, 3, v6
    s_lshl_b32 s66, s61, 7
    s_lshl_b32 s67, s30, 6
    s_add_u32 s66, s66, s67
    v_add_u32 v7, s66, v2
    v_lshlrev_b32 v30, 11, v7
    v_lshl_add_u32 v30, v6, 1, v30
    s_lshl_b32 s66, s66, 3
    s_add_u32 s66, s66, 16777216
    v_lshl_add_u32 v31, v6, 12, s66
    v_lshl_add_u32 v31, v2, 4, v31
    v_lshlrev_b32 v32, 3, v7
    v_add_u32 v32, 25165824, v32
    v_cmp_eq_u32 vcc, 0, v4
    v_lshl_add_u32 v7, v2, 4, s68
    s_lshl_b32 s66, s61, 4
    v_add_u32 v33, s66, v2
    v_cndmask_b32 v7, v33, v7, vcc
    v_lshlrev_b32 v7, 8, v7
    v_add_u32 v33, 26214528, v7
    s_lshl_b32 s66, s65, 13
    s_add_u32 s66, s66, 131072
    v_lshl_add_u32 v7, v4, 12, s66
    v_lshl_add_u32 v7, v5, 9, v7
    v_lshl_add_u32 v34, v2, 4, v7
    s_lshl_b32 s18, s62, 4
    s_add_u32 s18, s18, s61
    s_lshl_b32 s18, s18, 14
    s_add_u32 s18, s18, s8
    s_add_u32 s18, s18, 16777216
    v_mov_b32 v4, 114880
    v_mov_b32 v5, 1
    s_cmp_eq_u32 s64, 7
    s_cbranch_scc1 L_Asp3
    s_waitcnt vmcnt(0)
    s_mov_b64 exec, 1
    ds_add_rtn_u32 v5, v4, v5
    s_mov_b64 exec, -1
    s_waitcnt lgkmcnt(0)
    v_readfirstlane_b32 s66, v5
    s_nop 1
    s_cmp_lg_u32 s66, 3
    s_cbranch_scc1 L_only8
    v_mov_b32 v5, 1
    s_mov_b64 exec, 1
    buffer_store_dword v5, off, s[40:43], s16 offset:0 sc1
    s_mov_b64 exec, -1
L_only8:
    s_mov_b32 s66, 0
    buffer_load_dwordx4 v[40:43], v30, s[32:35], s66 offen
    s_mov_b32 s66, 32768
    buffer_load_dwordx4 v[44:47], v30, s[32:35], s66 offen
    s_mov_b32 s66, 65536
    buffer_load_dwordx4 v[48:51], v30, s[32:35], s66 offen
    s_mov_b32 s66, 98304
    buffer_load_dwordx4 v[52:55], v30, s[32:35], s66 offen
    buffer_store_dwordx4 v[24:27], v244, s[40:43], s14 offen offset:0 sc1
    buffer_store_dwordx4 v[24:27], v244, s[40:43], s14 offen offset:1024 sc1
    buffer_store_dwordx4 v[24:27], v244, s[40:43], s14 offen offset:2048 sc1
    buffer_store_dwordx4 v[24:27], v244, s[40:43], s14 offen offset:3072 sc1
    s_barrier
    s_add_u32 s66, s16, 256
    s_sub_u32 s67, s16, 1536
    s_cmp_eq_u32 s64, 6
    s_cselect_b32 s66, s67, s66
    v_mov_b32 v6, s66
    s_cmp_lg_u32 s65, 0
    s_cbranch_scc1 L_only9
    v_mov_b32 v1, 0
    buffer_load_dword v1, v6, s[40:43], 0 offen sc1
L_only9:
    s_mov_b32 s70, 1145324612
    s_mov_b32 s71, 1145324612
    s_call_b64 s[0:1], L_g2w
    s_cmp_lg_u32 s31, 1
    s_cbranch_scc1 L_only10
    ds_write_b128 v233, v[136:139] offset:0
    ds_write_b128 v233, v[140:143] offset:1024
    ds_write_b128 v233, v[144:147] offset:2048
    ds_write_b128 v233, v[148:151] offset:3072
    ds_write_b128 v233, v[152:155] offset:8192
    ds_write_b128 v233, v[156:159] offset:9216
    ds_write_b128 v233, v[160:163] offset:10240
    ds_write_b128 v233, v[164:167] offset:11264
L_only10:
HM14:
    s_cbranch_execz HM15
    s_cmp_lg_u32 s65, 0
    s_cbranch_scc1 L_only11
    s_waitcnt vmcnt(4)
    s_mov_b32 s69, 524288
    s_branch L_fh_chk
L_fh_ld:
    s_sleep 4
L_fh_ld0:
    buffer_load_dword v1, v6, s[40:43], 0 offen sc1
    s_waitcnt vmcnt(0)
L_fh_chk:
    v_cmp_ne_u32 vcc, 0, v1
    s_sub_u32 s69, s69, 1
    s_cmp_eq_u32 s69, 0
    s_cbranch_scc1 L_fh_ok
    s_cmp_eq_u64 vcc, -1
    s_cbranch_scc0 L_fh_ld
L_fh_ok:
    v_mov_b32 v5, 1
    ds_write_b32 v4, v5 offset:8
L_only11:
    s_mov_b32 s69, 33554432
    s_branch L_fh_r
L_fh_s:
    s_sleep 1
L_fh_r:
    ds_read_b32 v5, v4 offset:8
    s_waitcnt lgkmcnt(0)
    v_readfirstlane_b32 s66, v5
    s_sub_u32 s69, s69, 1
    s_cmp_eq_u32 s69, 0
    s_cbranch_scc1 L_fh_go
    s_cmp_eq_u32 s66, 0
    s_cbranch_scc1 L_fh_s
L_fh_go:
    s_mov_b32 s70, 1146373204
    s_mov_b32 s71, 1146373204
    s_call_b64 s[0:1], L_g2i
    s_waitcnt vmcnt(8)
    s_barrier
    s_cmp_lg_u32 s65, 0
    s_cbranch_scc1 L_only12
    v_mov_b32 v37, 0
    buffer_load_dword v37, v249, s[40:43], 0 offen sc1
L_only12:
    s_mov_b32 s70, 1161053492
    s_mov_b32 s71, 1161053492
    s_call_b64 s[0:1], L_g2i
    s_waitcnt vmcnt(8)
    s_cmp_lg_u32 s65, 0
    s_cbranch_scc1 L_only13
    s_mov_b32 s69, 524288
    s_branch L_fh2_chk
L_fh2_ld:
    s_sleep 4
L_fh2_ld0:
    buffer_load_dword v37, v249, s[40:43], 0 offen sc1
    s_waitcnt vmcnt(0)
L_fh2_chk:
    v_cmp_ne_u32 vcc, 0, v37
    s_sub_u32 s69, s69, 1
    s_cmp_eq_u32 s69, 0
    s_cbranch_scc1 L_fh2_ok
    s_cmp_eq_u64 vcc, -1
    s_cbranch_scc0 L_fh2_ld
L_fh2_ok:
L_only13:
L_k4:
    s_setprio 1
    s_barrier
    s_mov_b32 s70, 1396986692
    s_mov_b32 s71, 1396986692
    s_call_b64 s[0:1], L_g2i
    ds_read_b64_tr_b16 v[8:9], v250 offset:0
    ds_read_b64_tr_b16 v[10:11], v250 offset:64
    ds_read_b64_tr_b16 v[12:13], v252 offset:512
    ds_read_b64_tr_b16 v[14:15], v252 offset:576
    ds_read_b64_tr_b16 v[16:17], v250 offset:2048
    ds_read_b64_tr_b16 v[18:19], v250 offset:2112
    ds_read_b64_tr_b16 v[20:21], v252 offset:2560
    ds_read_b64_tr_b16 v[22:23], v252 offset:2624
    s_lshl_b32 s66, s65, 4
    v_lshl_add_u32 v5, v0, 2, s66
    v_add_u32 v4, 114896, v5
    ds_read_b32 v28, v4
    s_waitcnt lgkmcnt(0)
    s_waitcnt vmcnt(8)
    s_barrier
    s_mov_b32 s70, 876950597
    s_mov_b32 s71, 876950597
    s_call_b64 s[0:1], L_g2i
    s_waitcnt vmcnt(8)
    s_barrier
    s_mov_b32 s70, 1146307667
    s_mov_b32 s71, 1146307667
    s_call_b64 s[0:1], L_g2i
    s_waitcnt vmcnt(8)
    s_barrier
    s_mov_b32 s70, 1161053492
    s_mov_b32 s71, 1161053492
    s_call_b64 s[0:1], L_g2i
    s_waitcnt vmcnt(8)
    s_barrier
    s_mov_b32 s70, 1396986692
    s_mov_b32 s71, 1396986692
    s_call_b64 s[0:1], L_g2i
    s_waitcnt vmcnt(8)
    s_barrier
    s_mov_b32 s70, 876950597
    s_mov_b32 s71, 876950597
    s_call_b64 s[0:1], L_g2i
    s_waitcnt vmcnt(8)
    s_barrier
    s_mov_b32 s70, 1146307667
    s_mov_b32 s71, 1146307667
    s_call_b64 s[0:1], L_g2i
    s_waitcnt vmcnt(8)
    s_barrier
    s_mov_b32 s70, 1161053492
    s_mov_b32 s71, 1161053492
    s_call_b64 s[0:1], L_g2i
    s_waitcnt vmcnt(8)
    s_barrier
    s_mov_b32 s70, 1396986692
    s_mov_b32 s71, 1396986692
    s_call_b64 s[0:1], L_g2i
    buffer_store_dwordx4 v[8:11], v244, s[40:43], s18 offen offset:0 sc1
    buffer_store_dwordx4 v[12:15], v244, s[40:43], s18 offen offset:1024 sc1
    buffer_store_dwordx4 v[16:19], v244, s[40:43], s18 offen offset:2048 sc1
    buffer_store_dwordx4 v[20:23], v244, s[40:43], s18 offen offset:3072 sc1
    s_lshl_b32 s66, s61, 4
    s_add_u32 s66, s66, s62
    s_lshl_b32 s66, s66, 6
    s_add_u32 s66, s66, 25165824
    s_mov_b64 exec, 15
    buffer_store_dword v28, v5, s[40:43], s66 offen sc1
    s_mov_b64 exec, -1
HM15:
    s_cbranch_execz HM16
    s_waitcnt vmcnt(13)
    s_barrier
    s_mov_b32 s70, 876950597
    s_mov_b32 s71, 876950597
    s_call_b64 s[0:1], L_g2i
    s_waitcnt vmcnt(13)
    s_barrier
    s_mov_b32 s70, 1146307667
    s_mov_b32 s71, 1146307667
    s_call_b64 s[0:1], L_g2i
    s_waitcnt vmcnt(8)
    s_barrier
    s_mov_b32 s70, 1161053492
    s_mov_b32 s71, 1161053492
    s_call_b64 s[0:1], L_g2i
    s_cmp_lg_u32 s65, 0
    s_cbranch_scc1 L_only14
    v_mov_b32 v1, 1
    s_mov_b64 exec, 1
    buffer_store_dword v1, off, s[40:43], s16 offset:128 sc1
    s_mov_b64 exec, -1
L_only14:
    s_waitcnt vmcnt(8)
    s_barrier
    s_mov_b32 s70, 1396986692
    s_mov_b32 s71, 1396986692
    s_call_b64 s[0:1], L_g2i
    s_waitcnt vmcnt(8)
    s_barrier
    s_mov_b32 s70, 876950597
    s_mov_b32 s71, 876950597
    s_call_b64 s[0:1], L_g2i
    s_waitcnt vmcnt(8)
    s_barrier
    s_mov_b32 s70, 1146307667
    s_mov_b32 s71, 1146307667
    s_call_b64 s[0:1], L_g2i
    s_waitcnt vmcnt(8)
    s_barrier
    s_mov_b32 s70, 1161053492
    s_mov_b32 s71, 1161053492
    s_call_b64 s[0:1], L_g2i
    s_waitcnt vmcnt(8)
    s_barrier
    s_mov_b32 s70, 1396986692
    s_mov_b32 s71, 1396986692
    s_call_b64 s[0:1], L_g2i
    s_waitcnt vmcnt(8)
    s_barrier
    s_mov_b32 s70, 876950597
    s_mov_b32 s71, 876950597
    s_call_b64 s[0:1], L_g2i
    s_waitcnt vmcnt(8)
    s_barrier
    s_mov_b32 s70, 1146307667
    s_mov_b32 s71, 1146307667
    s_call_b64 s[0:1], L_g2i
    s_waitcnt vmcnt(8)
    s_barrier
    s_mov_b32 s70, 1161053492
    s_mov_b32 s71, 1161053492
    s_call_b64 s[0:1], L_g2i
    s_waitcnt vmcnt(8)
    s_barrier
    s_cmp_lg_u32 s65, 0
    s_cbranch_scc1 L_only15
    v_mov_b32 v37, 0
    buffer_load_dword v37, v33, s[40:43], 0 offen sc1
L_only15:
    s_mov_b32 s70, 1396986692
    s_mov_b32 s71, 1396986692
    s_call_b64 s[0:1], L_g2i
    s_waitcnt vmcnt(8)
    s_barrier
    s_mov_b32 s70, 876885060
    s_mov_b32 s71, 876885060
    s_call_b64 s[0:1], L_g2i
    s_waitcnt vmcnt(8)
    s_cmp_lg_u32 s65, 0
    s_cbranch_scc1 L_only16
    s_mov_b32 s69, 524288
    s_branch L_fz_chk
L_fz_ld:
    s_sleep 4
L_fz_ld0:
    buffer_load_dword v37, v33, s[40:43], 0 offen sc1
    s_waitcnt vmcnt(0)
L_fz_chk:
    v_cmp_ne_u32 vcc, 0, v37
    s_sub_u32 s69, s69, 1
    s_cmp_eq_u32 s69, 0
    s_cbranch_scc1 L_fz_ok
    s_cmp_eq_u64 vcc, -1
    s_cbranch_scc0 L_fz_ld
L_fz_ok:
L_only16:
    s_barrier
    s_mov_b32 s66, 16384
    buffer_load_dwordx4 v[56:59], v31, s[40:43], 0 offen offset:0 sc1
    buffer_load_dwordx4 v[60:63], v31, s[40:43], s66 offen offset:0 sc1
    buffer_load_dwordx4 v[64:67], v31, s[40:43], 0 offen offset:256 sc1
    buffer_load_dwordx4 v[68:71], v31, s[40:43], s66 offen offset:256 sc1
    buffer_load_dwordx2 v[72:73], v32, s[40:43], 0 offen offset:0 sc1
    buffer_load_dwordx2 v[74:75], v32, s[40:43], 0 offen offset:128 sc1
    buffer_load_dwordx2 v[76:77], v32, s[40:43], 0 offen offset:256 sc1
    buffer_load_dwordx2 v[78:79], v32, s[40:43], 0 offen offset:384 sc1
    s_waitcnt vmcnt(8)
    s_barrier
    s_setprio 0
    s_xor_b32 s68, s60, 1
    s_lshl_b32 s68, s68, 14
    s_add_u32 s68, s68, s8
    s_add_u32 s68, s68, 33554432
    s_mov_b32 s67, 0xffff0000
HM16:
    s_cbranch_execz HM17
    s_waitcnt vmcnt(0)
    v_lshlrev_b32 v4, 16, v40
    v_lshlrev_b32 v5, 16, v56
    v_mul_f32 v80, v4, v5
    v_and_b32 v4, s67, v40
    v_and_b32 v5, s67, v56
    v_mul_f32 v81, v4, v5
    v_lshlrev_b32 v4, 16, v41
    v_lshlrev_b32 v5, 16, v57
    v_mul_f32 v82, v4, v5
    v_and_b32 v4, s67, v41
    v_and_b32 v5, s67, v57
    v_mul_f32 v83, v4, v5
    v_lshlrev_b32 v4, 16, v42
    v_lshlrev_b32 v5, 16, v60
    v_mul_f32 v84, v4, v5
    v_and_b32 v4, s67, v42
    v_and_b32 v5, s67, v60
    v_mul_f32 v85, v4, v5
    v_lshlrev_b32 v4, 16, v43
    v_lshlrev_b32 v5, 16, v61
    v_mul_f32 v86, v4, v5
    v_and_b32 v4, s67, v43
    v_and_b32 v5, s67, v61
    v_mul_f32 v87, v4, v5
    v_lshlrev_b32 v4, 16, v44
    v_lshlrev_b32 v5, 16, v58
    v_mul_f32 v88, v4, v5
    v_and_b32 v4, s67, v44
    v_and_b32 v5, s67, v58
    v_mul_f32 v89, v4, v5
    v_lshlrev_b32 v4, 16, v45
    v_lshlrev_b32 v5, 16, v59
    v_mul_f32 v90, v4, v5
    v_and_b32 v4, s67, v45
    v_and_b32 v5, s67, v59
    v_mul_f32 v91, v4, v5
    v_lshlrev_b32 v4, 16, v46
    v_lshlrev_b32 v5, 16, v62
    v_mul_f32 v92, v4, v5
    v_and_b32 v4, s67, v46
    v_and_b32 v5, s67, v62
    v_mul_f32 v93, v4, v5
    v_lshlrev_b32 v4, 16, v47
    v_lshlrev_b32 v5, 16, v63
    v_mul_f32 v94, v4, v5
    v_and_b32 v4, s67, v47
    v_and_b32 v5, s67, v63
    v_mul_f32 v95, v4, v5
    v_lshlrev_b32 v4, 16, v48
    v_lshlrev_b32 v5, 16, v64
    v_mul_f32 v96, v4, v5
    v_and_b32 v4, s67, v48
    v_and_b32 v5, s67, v64
    v_mul_f32 v97, v4, v5
    v_lshlrev_b32 v4, 16, v49
    v_lshlrev_b32 v5, 16, v65
    v_mul_f32 v98, v4, v5
    v_and_b32 v4, s67, v49
    v_and_b32 v5, s67, v65
    v_mul_f32 v99, v4, v5
    v_lshlrev_b32 v4, 16, v50
    v_lshlrev_b32 v5, 16, v68
    v_mul_f32 v100, v4, v5
    v_and_b32 v4, s67, v50
    v_and_b32 v5, s67, v68
    v_mul_f32 v101, v4, v5
    v_lshlrev_b32 v4, 16, v51
    v_lshlrev_b32 v5, 16, v69
    v_mul_f32 v102, v4, v5
    v_and_b32 v4, s67, v51
    v_and_b32 v5, s67, v69
    v_mul_f32 v103, v4, v5
    v_lshlrev_b32 v4, 16, v52
    v_lshlrev_b32 v5, 16, v66
    v_mul_f32 v104, v4, v5
    v_and_b32 v4, s67, v52
    v_and_b32 v5, s67, v66
    v_mul_f32 v105, v4, v5
    v_lshlrev_b32 v4, 16, v53
    v_lshlrev_b32 v5, 16, v67
    v_mul_f32 v106, v4, v5
    v_and_b32 v4, s67, v53
    v_and_b32 v5, s67, v67
    v_mul_f32 v107, v4, v5
    v_lshlrev_b32 v4, 16, v54
    v_lshlrev_b32 v5, 16, v70
    v_mul_f32 v108, v4, v5
    v_and_b32 v4, s67, v54
    v_and_b32 v5, s67, v70
    v_mul_f32 v109, v4, v5
    v_lshlrev_b32 v4, 16, v55
    v_lshlrev_b32 v5, 16, v71
    v_mul_f32 v110, v4, v5
    v_and_b32 v4, s67, v55
    v_and_b32 v5, s67, v71
    v_mul_f32 v111, v4, v5
    v_mul_f32 v80, v80, v72
    v_mul_f32 v81, v81, v72
    v_mul_f32 v82, v82, v72
    v_mul_f32 v83, v83, v72
    v_mul_f32 v84, v84, v72
    v_mul_f32 v85, v85, v72
    v_mul_f32 v86, v86, v72
    v_mul_f32 v87, v87, v72
    v_mul_f32 v88, v88, v74
    v_mul_f32 v89, v89, v74
    v_mul_f32 v90, v90, v74
    v_mul_f32 v91, v91, v74
    v_mul_f32 v92, v92, v74
    v_mul_f32 v93, v93, v74
    v_mul_f32 v94, v94, v74
    v_mul_f32 v95, v95, v74
    v_mul_f32 v96, v96, v76
    v_mul_f32 v97, v97, v76
    v_mul_f32 v98, v98, v76
    v_mul_f32 v99, v99, v76
    v_mul_f32 v100, v100, v76
    v_mul_f32 v101, v101, v76
    v_mul_f32 v102, v102, v76
    v_mul_f32 v103, v103, v76
    v_mul_f32 v104, v104, v78
    v_mul_f32 v105, v105, v78
    v_mul_f32 v106, v106, v78
    v_mul_f32 v107, v107, v78
    v_mul_f32 v108, v108, v78
    v_mul_f32 v109, v109, v78
    v_mul_f32 v110, v110, v78
    v_mul_f32 v111, v111, v78
    s_mov_b32 s69, 524288
    s_barrier
    buffer_load_dwordx4 v[176:179], v244, s[40:43], s68 offen offset:0 sc1
    buffer_load_dwordx4 v[180:183], v244, s[40:43], s68 offen offset:1024 sc1
    buffer_load_dwordx4 v[184:187], v244, s[40:43], s68 offen offset:2048 sc1
    buffer_load_dwordx4 v[188:191], v244, s[40:43], s68 offen offset:3072 sc1
L_fp_nl:
    ds_read_b128 v[112:115], v34 offset:0
    ds_read_b128 v[116:119], v34 offset:256
    ds_read_b128 v[120:123], v34 offset:1024
    ds_read_b128 v[124:127], v34 offset:1280
    ds_read_b128 v[128:131], v34 offset:2048
    ds_read_b128 v[132:135], v34 offset:2304
    ds_read_b128 v[136:139], v34 offset:3072
    ds_read_b128 v[140:143], v34 offset:3328
    s_waitcnt lgkmcnt(6)
    v_fmac_f32 v80, v112, v73
    v_fmac_f32 v81, v113, v73
    v_fmac_f32 v82, v114, v73
    v_fmac_f32 v83, v115, v73
    v_fmac_f32 v84, v116, v73
    v_fmac_f32 v85, v117, v73
    v_fmac_f32 v86, v118, v73
    v_fmac_f32 v87, v119, v73
    s_waitcnt lgkmcnt(4)
    v_fmac_f32 v88, v120, v75
    v_fmac_f32 v89, v121, v75
    v_fmac_f32 v90, v122, v75
    v_fmac_f32 v91, v123, v75
    v_fmac_f32 v92, v124, v75
    v_fmac_f32 v93, v125, v75
    v_fmac_f32 v94, v126, v75
    v_fmac_f32 v95, v127, v75
    s_waitcnt lgkmcnt(2)
    v_fmac_f32 v96, v128, v77
    v_fmac_f32 v97, v129, v77
    v_fmac_f32 v98, v130, v77
    v_fmac_f32 v99, v131, v77
    v_fmac_f32 v100, v132, v77
    v_fmac_f32 v101, v133, v77
    v_fmac_f32 v102, v134, v77
    v_fmac_f32 v103, v135, v77
    s_waitcnt lgkmcnt(0)
    v_fmac_f32 v104, v136, v79
    v_fmac_f32 v105, v137, v79
    v_fmac_f32 v106, v138, v79
    v_fmac_f32 v107, v139, v79
    v_fmac_f32 v108, v140, v79
    v_fmac_f32 v109, v141, v79
    v_fmac_f32 v110, v142, v79
    v_fmac_f32 v111, v143, v79
HM17:
    s_cbranch_execz L_ret0
    s_branch L_fp_chk
L_fp_ld:
    s_sleep 2
    buffer_load_dwordx4 v[176:179], v244, s[40:43], s68 offen offset:0 sc1
    buffer_load_dwordx4 v[180:183], v244, s[40:43], s68 offen offset:1024 sc1
    buffer_load_dwordx4 v[184:187], v244, s[40:43], s68 offen offset:2048 sc1
    buffer_load_dwordx4 v[188:191], v244, s[40:43], s68 offen offset:3072 sc1
L_fp_chk:
    s_waitcnt vmcnt(0)
    v_max3_u32 v4, v176, v177, v178
    v_max3_u32 v5, v179, v180, v181
    v_max3_u32 v5, v5, v182, v183
    v_max3_u32 v4, v4, v184, v185
    v_max3_u32 v5, v5, v186, v187
    v_max3_u32 v4, v4, v188, v189
    v_max3_u32 v5, v5, v190, v191
    v_max_u32 v4, v4, v5
    v_cmp_eq_u32 vcc, -1, v4
    s_sub_u32 s69, s69, 1
    s_nop 1
    s_cselect_b64 vcc, 0, vcc
    s_cmp_eq_u64 vcc, 0
    s_cbranch_scc0 L_fp_ld
L_fp_ok:
    v_lshlrev_b32 v4, 16, v176
    v_fmac_f32 v80, v4, v73
    v_and_b32 v4, s67, v176
    v_fmac_f32 v81, v4, v73
    v_lshlrev_b32 v4, 16, v177
    v_fmac_f32 v82, v4, v73
    v_and_b32 v4, s67, v177
    v_fmac_f32 v83, v4, v73
    v_lshlrev_b32 v4, 16, v178
    v_fmac_f32 v84, v4, v73
    v_and_b32 v4, s67, v178
    v_fmac_f32 v85, v4, v73
    v_lshlrev_b32 v4, 16, v179
    v_fmac_f32 v86, v4, v73
    v_and_b32 v4, s67, v179
    v_fmac_f32 v87, v4, v73
    v_cvt_pk_bf16_f32 v112, v80, v81
    v_cvt_pk_bf16_f32 v113, v82, v83
    v_cvt_pk_bf16_f32 v114, v84, v85
    v_cvt_pk_bf16_f32 v115, v86, v87
    s_mov_b32 s66, 0
    buffer_store_dwordx4 v[112:115], v30, s[44:47], s66 offen sc1
    v_lshlrev_b32 v4, 16, v180
    v_fmac_f32 v88, v4, v75
    v_and_b32 v4, s67, v180
    v_fmac_f32 v89, v4, v75
    v_lshlrev_b32 v4, 16, v181
    v_fmac_f32 v90, v4, v75
    v_and_b32 v4, s67, v181
    v_fmac_f32 v91, v4, v75
    v_lshlrev_b32 v4, 16, v182
    v_fmac_f32 v92, v4, v75
    v_and_b32 v4, s67, v182
    v_fmac_f32 v93, v4, v75
    v_lshlrev_b32 v4, 16, v183
    v_fmac_f32 v94, v4, v75
    v_and_b32 v4, s67, v183
    v_fmac_f32 v95, v4, v75
    v_cvt_pk_bf16_f32 v116, v88, v89
    v_cvt_pk_bf16_f32 v117, v90, v91
    v_cvt_pk_bf16_f32 v118, v92, v93
    v_cvt_pk_bf16_f32 v119, v94, v95
    s_mov_b32 s66, 32768
    buffer_store_dwordx4 v[116:119], v30, s[44:47], s66 offen sc1
    v_lshlrev_b32 v4, 16, v184
    v_fmac_f32 v96, v4, v77
    v_and_b32 v4, s67, v184
    v_fmac_f32 v97, v4, v77
    v_lshlrev_b32 v4, 16, v185
    v_fmac_f32 v98, v4, v77
    v_and_b32 v4, s67, v185
    v_fmac_f32 v99, v4, v77
    v_lshlrev_b32 v4, 16, v186
    v_fmac_f32 v100, v4, v77
    v_and_b32 v4, s67, v186
    v_fmac_f32 v101, v4, v77
    v_lshlrev_b32 v4, 16, v187
    v_fmac_f32 v102, v4, v77
    v_and_b32 v4, s67, v187
    v_fmac_f32 v103, v4, v77
    v_cvt_pk_bf16_f32 v120, v96, v97
    v_cvt_pk_bf16_f32 v121, v98, v99
    v_cvt_pk_bf16_f32 v122, v100, v101
    v_cvt_pk_bf16_f32 v123, v102, v103
    s_mov_b32 s66, 65536
    buffer_store_dwordx4 v[120:123], v30, s[44:47], s66 offen sc1
    v_lshlrev_b32 v4, 16, v188
    v_fmac_f32 v104, v4, v79
    v_and_b32 v4, s67, v188
    v_fmac_f32 v105, v4, v79
    v_lshlrev_b32 v4, 16, v189
    v_fmac_f32 v106, v4, v79
    v_and_b32 v4, s67, v189
    v_fmac_f32 v107, v4, v79
    v_lshlrev_b32 v4, 16, v190
    v_fmac_f32 v108, v4, v79
    v_and_b32 v4, s67, v190
    v_fmac_f32 v109, v4, v79
    v_lshlrev_b32 v4, 16, v191
    v_fmac_f32 v110, v4, v79
    v_and_b32 v4, s67, v191
    v_fmac_f32 v111, v4, v79
    v_cvt_pk_bf16_f32 v124, v104, v105
    v_cvt_pk_bf16_f32 v125, v106, v107
    v_cvt_pk_bf16_f32 v126, v108, v109
    v_cvt_pk_bf16_f32 v127, v110, v111
    s_mov_b32 s66, 98304
    buffer_store_dwordx4 v[124:127], v30, s[44:47], s66 offen sc1
    s_endpgm
L_g2i:
    s_add_u32 s66, s3, s8
    s_add_u32 m0, s66, 49152
    s_lshr_b64 s[70:71], s[70:71], s101
    s_and_b32 s10, s70, 15
    s_add_u32 s10, s10, s9
    s_sub_u32 s13, s10, 28
    s_cselect_b32 s10, s10, s13
    s_lshl_b32 s13, s10, 17
    s_add_u32 s13, s13, s7
    buffer_load_dwordx4 v245, s[36:39], s13 offen offset:0 lds
    buffer_load_dwordx4 v246, s[36:39], s13 offen offset:1024 lds
    buffer_load_dwordx4 v247, s[36:39], s13 offen offset:2048 lds
    buffer_load_dwordx4 v248, s[36:39], s13 offen offset:3072 lds
    s_mov_b32 m0, s66
    s_lshl_b32 s10, s10, 14
    s_add_u32 s10, s10, s6
    buffer_load_dwordx4 v244, s[40:43], s10 offen offset:0 sc1 lds
    buffer_load_dwordx4 v244, s[40:43], s10 offen offset:1024 sc1 lds
    buffer_load_dwordx4 v244, s[40:43], s10 offen offset:2048 sc1 lds
    buffer_load_dwordx4 v244, s[40:43], s10 offen offset:3072 sc1 lds
    s_add_u32 s9, s9, 1
    s_add_u32 s3, s3, 16384
    s_cmp_eq_u32 s3, 49152
    s_cselect_b32 s3, 0, s3
    s_setpc_b64 s[0:1]
L_g2w:
    s_add_u32 s66, s3, s8
    s_add_u32 m0, s66, 49152
    s_lshr_b64 s[70:71], s[70:71], s101
    s_and_b32 s10, s70, 15
    s_add_u32 s10, s10, s9
    s_sub_u32 s13, s10, 28
    s_cselect_b32 s10, s10, s13
    s_lshl_b32 s13, s10, 17
    s_add_u32 s13, s13, s7
    buffer_load_dwordx4 v245, s[36:39], s13 offen offset:0 lds
    buffer_load_dwordx4 v246, s[36:39], s13 offen offset:1024 lds
    buffer_load_dwordx4 v247, s[36:39], s13 offen offset:2048 lds
    buffer_load_dwordx4 v248, s[36:39], s13 offen offset:3072 lds
    s_mov_b32 m0, s66
    s_lshl_b32 s10, s10, 14
    s_add_u32 s10, s10, s6
    s_add_u32 s9, s9, 1
    s_add_u32 s3, s3, 16384
    s_cmp_eq_u32 s3, 49152
    s_cselect_b32 s3, 0, s3
    s_setpc_b64 s[0:1]
L_Pcode:
HQ0:
    s_cbranch_execz HQ1
L_Aspare:
    s_cmp_lg_u32 s65, 3
    s_cbranch_scc1 L_only17
    v_and_b32 v4, 7, v0
    v_lshlrev_b32 v5, 8, v4
    v_and_b32 v6, 8, v0
    v_lshl_add_u32 v5, v6, 4, v5
    s_lshl_b32 s66, s61, 2
    v_add_u32 v6, s66, v3
    v_lshl_add_u32 v5, v6, 11, v5
    v_lshl_add_u32 v4, v4, 2, 4
    s_mul_i32 s66, s63, 3670016
    s_mov_b32 s67, 4
L_warm:
    v_subrev_u32 v6, 28, v4
    v_min_u32 v4, v4, v6
    v_lshl_add_u32 v6, v4, 17, v5
    buffer_load_dword v38, v6, s[36:39], s66 offen
    v_add_u32 v4, 1, v4
    s_sub_u32 s67, s67, 1
    s_cmp_lg_u32 s67, 0
    s_cbranch_scc1 L_warm
L_only17:
    s_branch L_go0
L_Asp2:
    s_barrier
    s_barrier
    s_barrier
    s_cmp_lg_u32 s65, 3
    s_cbranch_scc1 L_only18
    s_mov_b32 s67, 6
L_warm2:
    v_subrev_u32 v6, 28, v4
    v_min_u32 v4, v4, v6
    v_lshl_add_u32 v6, v4, 17, v5
    buffer_load_dword v38, v6, s[36:39], s66 offen
    v_add_u32 v4, 1, v4
    s_sub_u32 s67, s67, 1
    s_cmp_lg_u32 s67, 0
    s_cbranch_scc1 L_warm2
L_only18:
    s_branch L_hdone
L_Asp3:
    s_mov_b32 s66, 0
    buffer_load_dwordx4 v[40:43], v30, s[32:35], s66 offen
    s_mov_b32 s66, 32768
    buffer_load_dwordx4 v[44:47], v30, s[32:35], s66 offen
    s_mov_b32 s66, 65536
    buffer_load_dwordx4 v[48:51], v30, s[32:35], s66 offen
    s_mov_b32 s66, 98304
    buffer_load_dwordx4 v[52:55], v30, s[32:35], s66 offen
    buffer_store_dwordx4 v[24:27], v244, s[40:43], s14 offen offset:0 sc1
    buffer_store_dwordx4 v[24:27], v244, s[40:43], s14 offen offset:1024 sc1
    buffer_store_dwordx4 v[24:27], v244, s[40:43], s14 offen offset:2048 sc1
    buffer_store_dwordx4 v[24:27], v244, s[40:43], s14 offen offset:3072 sc1
    v_readfirstlane_b32 s66, v249
    s_add_u32 s10, s6, 32768
    s_add_u32 s11, s6, 16384
    v_mov_b32 v6, s66
    s_cmp_lg_u32 s65, 0
    s_cbranch_scc1 L_only19
    s_mov_b32 s69, 524288
    s_branch L_fh0_ld0
L_fh0_ld:
    s_sleep 4
L_fh0_ld0:
    buffer_load_dword v1, v6, s[40:43], 0 offen sc1
    s_waitcnt vmcnt(0)
L_fh0_chk:
    v_cmp_ne_u32 vcc, 0, v1
    s_sub_u32 s69, s69, 1
    s_cmp_eq_u32 s69, 0
    s_cbranch_scc1 L_fh0_ok
    s_cmp_eq_u64 vcc, -1
    s_cbranch_scc0 L_fh0_ld
L_fh0_ok:
    v_mov_b32 v5, 1
    ds_write_b32 v4, v5 offset:8
L_only19:
    s_mov_b32 s69, 33554432
    s_branch L_fh0_r
L_fh0_s:
    s_sleep 1
L_fh0_r:
    ds_read_b32 v5, v4 offset:8
    s_waitcnt lgkmcnt(0)
    v_readfirstlane_b32 s66, v5
    s_sub_u32 s69, s69, 1
    s_cmp_eq_u32 s69, 0
    s_cbranch_scc1 L_fh0_go
    s_cmp_eq_u32 s66, 0
    s_cbranch_scc1 L_fh0_s
L_fh0_go:
    s_add_u32 m0, s8, 0
    s_nop 0
    buffer_load_dwordx4 v244, s[40:43], s6 offen offset:0 sc1 lds
    buffer_load_dwordx4 v244, s[40:43], s6 offen offset:1024 sc1 lds
    buffer_load_dwordx4 v244, s[40:43], s6 offen offset:2048 sc1 lds
    buffer_load_dwordx4 v244, s[40:43], s6 offen offset:3072 sc1 lds
    s_add_u32 m0, s8, 16384
    s_nop 0
    buffer_load_dwordx4 v244, s[40:43], s10 offen offset:0 sc1 lds
    buffer_load_dwordx4 v244, s[40:43], s10 offen offset:1024 sc1 lds
    buffer_load_dwordx4 v244, s[40:43], s10 offen offset:2048 sc1 lds
    buffer_load_dwordx4 v244, s[40:43], s10 offen offset:3072 sc1 lds
    s_add_u32 m0, s8, 32768
    s_nop 0
    buffer_load_dwordx4 v244, s[40:43], s11 offen offset:0 sc1 lds
    buffer_load_dwordx4 v244, s[40:43], s11 offen offset:1024 sc1 lds
    buffer_load_dwordx4 v244, s[40:43], s11 offen offset:2048 sc1 lds
    buffer_load_dwordx4 v244, s[40:43], s11 offen offset:3072 sc1 lds
    s_waitcnt vmcnt(8)
    s_barrier
    s_waitcnt vmcnt(4)
    s_barrier
    s_cmp_lg_u32 s65, 0
    s_cbranch_scc1 L_only20
    v_mov_b32 v37, 0
    buffer_load_dword v37, v249, s[40:43], 0 offen sc1
L_only20:
    s_mov_b32 s70, 1145324612
    s_mov_b32 s71, 1145324612
    s_call_b64 s[0:1], L_g2i
    s_waitcnt vmcnt(8)
    s_cmp_lg_u32 s65, 0
    s_cbranch_scc1 L_only21
    s_mov_b32 s69, 524288
    s_branch L_fh1_chk
L_fh1_ld:
    s_sleep 4
L_fh1_ld0:
    buffer_load_dword v37, v249, s[40:43], 0 offen sc1
    s_waitcnt vmcnt(0)
L_fh1_chk:
    v_cmp_ne_u32 vcc, 0, v37
    s_sub_u32 s69, s69, 1
    s_cmp_eq_u32 s69, 0
    s_cbranch_scc1 L_fh1_ok
    s_cmp_eq_u64 vcc, -1
    s_cbranch_scc0 L_fh1_ld
L_fh1_ok:
L_only21:
    s_barrier
    s_mov_b32 s70, 1146373204
    s_mov_b32 s71, 1146373204
    s_call_b64 s[0:1], L_g2i
    s_waitcnt vmcnt(8)
    s_barrier
    s_mov_b32 s70, 1161053492
    s_mov_b32 s71, 1161053492
    s_call_b64 s[0:1], L_g2i
    s_waitcnt vmcnt(8)
    s_branch L_k4
HQ1:
    s_cbranch_execz L_Qret
L_Bspare:
    s_waitcnt lgkmcnt(0)
    v_mfma_f32_16x16x32_bf16 v[32:35], v[128:131], v[160:163], v[32:35]
    v_dot2_f32_bf16 v216, v192, v208, 0
    v_dot2_f32_bf16 v217, v200, v208, 0
    v_mfma_f32_16x16x32_bf16 v[36:39], v[128:131], v[164:167], v[36:39]
    v_dot2_f32_bf16 v216, v193, v209, v216
    v_dot2_f32_bf16 v217, v201, v209, v217
    v_mfma_f32_16x16x32_bf16 v[36:39], v[132:135], v[160:163], v[36:39]
    v_dot2_f32_bf16 v216, v194, v210, v216
    v_dot2_f32_bf16 v217, v202, v210, v217
    v_mfma_f32_16x16x32_bf16 v[40:43], v[128:131], v[168:171], v[40:43]
    v_dot2_f32_bf16 v216, v195, v211, v216
    v_dot2_f32_bf16 v217, v203, v211, v217
    v_mfma_f32_16x16x32_bf16 v[40:43], v[132:135], v[164:167], v[40:43]
    v_dot2_f32_bf16 v216, v196, v212, v216
    v_dot2_f32_bf16 v217, v204, v212, v217
    v_mfma_f32_16x16x32_bf16 v[40:43], v[136:139], v[160:163], v[40:43]
    v_dot2_f32_bf16 v216, v197, v213, v216
    v_dot2_f32_bf16 v217, v205, v213, v217
    v_mfma_f32_16x16x32_bf16 v[44:47], v[128:131], v[172:175], v[44:47]
    v_dot2_f32_bf16 v216, v198, v214, v216
    v_dot2_f32_bf16 v217, v206, v214, v217
    v_mfma_f32_16x16x32_bf16 v[44:47], v[132:135], v[168:171], v[44:47]
    v_dot2_f32_bf16 v216, v199, v215, v216
    v_dot2_f32_bf16 v217, v207, v215, v217
    v_mfma_f32_16x16x32_bf16 v[44:47], v[136:139], v[164:167], v[44:47]
    v_cvt_pk_bf16_f32 v32, v32, v33
    v_cvt_pk_bf16_f32 v33, v34, v35
    ds_write_b64 v12, v[32:33] offset:0
    v_mfma_f32_16x16x32_bf16 v[44:47], v[140:143], v[160:163], v[44:47]
    s_nop 0
    v_mfma_f32_16x16x32_bf16 v[48:51], v[128:131], v[176:179], v[48:51]
    v_cvt_pk_bf16_f32 v36, v36, v37
    v_cvt_pk_bf16_f32 v37, v38, v39
    ds_write_b64 v12, v[36:37] offset:2048
    v_mfma_f32_16x16x32_bf16 v[48:51], v[132:135], v[172:175], v[48:51]
    v_permlane32_swap_b32 v216, v217
    v_mfma_f32_16x16x32_bf16 v[48:51], v[136:139], v[168:171], v[48:51]
    v_add_f32 v216, v216, v217
    v_mfma_f32_16x16x32_bf16 v[48:51], v[140:143], v[164:167], v[48:51]
    v_cvt_pk_bf16_f32 v40, v40, v41
    v_cvt_pk_bf16_f32 v41, v42, v43
    ds_write_b64 v12, v[40:41] offset:4096
    v_mfma_f32_16x16x32_bf16 v[48:51], v[144:147], v[160:163], v[48:51]
    s_nop 0
    v_add_f32_dpp v216, v216, v216 row_shr:1 row_mask:0xf bank_mask:0xf bound_ctrl:0
    v_mfma_f32_16x16x32_bf16 v[52:55], v[128:131], v[180:183], v[52:55]
    s_nop 0
    v_add_f32_dpp v216, v216, v216 row_shr:2 row_mask:0xf bank_mask:0xf bound_ctrl:0
    v_mfma_f32_16x16x32_bf16 v[52:55], v[132:135], v[176:179], v[52:55]
    s_nop 0
    v_add_f32_dpp v216, v216, v216 row_shr:4 row_mask:0xf bank_mask:0xf bound_ctrl:0
    v_mfma_f32_16x16x32_bf16 v[52:55], v[136:139], v[172:175], v[52:55]
    v_cvt_pk_bf16_f32 v44, v44, v45
    v_cvt_pk_bf16_f32 v45, v46, v47
    ds_write_b64 v12, v[44:45] offset:6144
    v_mfma_f32_16x16x32_bf16 v[52:55], v[140:143], v[168:171], v[52:55]
    s_nop 0
    v_add_f32_dpp v216, v216, v216 row_shr:8 row_mask:0xf bank_mask:0xf bound_ctrl:0
    v_mfma_f32_16x16x32_bf16 v[52:55], v[144:147], v[164:167], v[52:55]
    s_nop 0
    v_add_f32_dpp v216, v216, v216 row_bcast:15 row_mask:0xa bank_mask:0xf
    v_mfma_f32_16x16x32_bf16 v[52:55], v[148:151], v[160:163], v[52:55]
    v_cvt_pk_bf16_f32 v216, v216, v216
    v_mfma_f32_16x16x32_bf16 v[56:59], v[128:131], v[184:187], v[56:59]
    v_lshlrev_b32 v216, 16, v216
    v_mfma_f32_16x16x32_bf16 v[56:59], v[132:135], v[180:183], v[56:59]
    v_cvt_pk_bf16_f32 v48, v48, v49
    v_cvt_pk_bf16_f32 v49, v50, v51
    ds_write_b64 v12, v[48:49] offset:8192
    v_mfma_f32_16x16x32_bf16 v[56:59], v[136:139], v[176:179], v[56:59]
    v_mul_f32 v216, 0xbfb8aa3b, v216
    v_mfma_f32_16x16x32_bf16 v[56:59], v[140:143], v[172:175], v[56:59]
    v_exp_f32 v216, v216
    v_mfma_f32_16x16x32_bf16 v[56:59], v[144:147], v[168:171], v[56:59]
    v_add_f32 v216, 1.0, v216
    v_mfma_f32_16x16x32_bf16 v[56:59], v[148:151], v[164:167], v[56:59]
    v_rcp_f32 v216, v216
    v_mfma_f32_16x16x32_bf16 v[56:59], v[152:155], v[160:163], v[56:59]
    v_cvt_pk_bf16_f32 v216, v216, v216
    v_mfma_f32_16x16x32_bf16 v[60:63], v[128:131], v[188:191], v[60:63]
    v_cvt_pk_bf16_f32 v52, v52, v53
    v_cvt_pk_bf16_f32 v53, v54, v55
    ds_write_b64 v12, v[52:53] offset:10240
    v_mfma_f32_16x16x32_bf16 v[60:63], v[132:135], v[184:187], v[60:63]
    v_lshlrev_b32 v216, 16, v216
    v_mfma_f32_16x16x32_bf16 v[60:63], v[136:139], v[180:183], v[60:63]
    v_sub_f32 v217, 1.0, v216
    v_mfma_f32_16x16x32_bf16 v[60:63], v[140:143], v[176:179], v[60:63]
    v_cvt_pk_bf16_f32 v217, v217, v217
    v_mfma_f32_16x16x32_bf16 v[60:63], v[144:147], v[172:175], v[60:63]
    v_lshlrev_b32 v217, 16, v217
    v_mfma_f32_16x16x32_bf16 v[60:63], v[148:151], v[168:171], v[60:63]
    s_mov_b32 exec_lo, 0x80000000
    s_mov_b32 exec_hi, 0x80000000
    ds_write_b64 v218, v[216:217]
    s_mov_b64 exec, -1
    v_mfma_f32_16x16x32_bf16 v[60:63], v[152:155], v[164:167], v[60:63]
    v_mfma_f32_16x16x32_bf16 v[60:63], v[156:159], v[160:163], v[60:63]
    v_cvt_pk_bf16_f32 v56, v56, v57
    v_cvt_pk_bf16_f32 v57, v58, v59
    ds_write_b64 v12, v[56:57] offset:12288
    s_nop 4
    v_cvt_pk_bf16_f32 v60, v60, v61
    v_cvt_pk_bf16_f32 v61, v62, v63
    ds_write_b64 v12, v[60:61] offset:14336
    s_waitcnt vmcnt(0) lgkmcnt(0)
    s_barrier
    ds_read_b64_tr_b16 v[72:73], v26 offset:0
    ds_read_b64_tr_b16 v[74:75], v26 offset:4096
    ds_read_b64_tr_b16 v[88:89], v26 offset:8192
    ds_read_b64_tr_b16 v[90:91], v26 offset:12288
    ds_read_b128 v[96:99], v23 offset:0
    ds_read_b128 v[112:115], v23 offset:8192
    ds_read_b128 v[100:103], v23 offset:1024
    ds_read_b128 v[116:119], v23 offset:9216
    ds_read_b128 v[104:107], v23 offset:2048
    ds_read_b128 v[120:123], v23 offset:10240
    ds_read_b128 v[108:111], v23 offset:3072
    ds_read_b128 v[124:127], v23 offset:11264
    ds_read_b64_tr_b16 v[76:77], v27 offset:0
    ds_read_b64_tr_b16 v[78:79], v27 offset:4096
    ds_read_b64_tr_b16 v[92:93], v27 offset:8192
    ds_read_b64_tr_b16 v[94:95], v27 offset:12288
    ds_read_b64_tr_b16 v[64:65], v24 offset:0
    ds_read_b64_tr_b16 v[66:67], v24 offset:4096
    ds_read_b64_tr_b16 v[80:81], v24 offset:8192
    ds_read_b64_tr_b16 v[82:83], v24 offset:12288
    ds_read_b64_tr_b16 v[68:69], v25 offset:0
    ds_read_b64_tr_b16 v[70:71], v25 offset:4096
    ds_read_b64_tr_b16 v[84:85], v25 offset:8192
    ds_read_b64_tr_b16 v[86:87], v25 offset:12288
    s_add_u32 s9, s9, 16384
    s_cmp_eq_u32 s9, 49152
    s_cselect_b32 s9, 0, s9
    v_add_u32 v23, s9, v18
    v_add_u32 v24, s9, v19
    v_add_u32 v25, s9, v20
    v_add_u32 v26, s9, v21
    v_add_u32 v27, s9, v22
    s_mov_b32 s68, 13
    s_waitcnt lgkmcnt(0)
    s_barrier
    s_branch L_s0
L_P0:
    s_lshl_b32 s66, s61, 3
    s_add_u32 s66, s66, s2
    s_lshl_b32 s66, s66, 15
    s_lshl_b32 s67, s63, 10
    s_add_u32 s66, s66, s67
    v_lshlrev_b32 v1, 4, v0
    v_add_u32 v3, s66, v1
    v_subrev_u32 v5, 6144, v3
    v_subrev_u32 v6, 4096, v3
    v_subrev_u32 v7, 2048, v3
    s_lshl_b32 s68, s65, 10
    s_add_u32 m0, s68, 133632
    s_lshl_b32 s67, s63, 12
    s_add_u32 s67, s67, s68
    s_waitcnt lgkmcnt(0)
    s_mov_b32 s44, s6
    s_mov_b32 s45, s7
    s_mov_b32 s46, 4194304
    s_mov_b32 s47, 0x20000
    s_mov_b32 s48, s8
    s_mov_b32 s49, s9
    s_mov_b32 s50, 4194304
    s_mov_b32 s51, 0x20000
    s_mov_b32 s52, s10
    s_mov_b32 s53, s11
    s_mov_b32 s54, 8192
    s_mov_b32 s55, 0x20000
    buffer_load_dwordx4 v1, s[52:55], s67 offen lds
    buffer_load_dwordx4 v[8:11], v5, s[44:47], 0 offen nt
    buffer_load_dwordx4 v[12:15], v6, s[44:47], 0 offen nt
    buffer_load_dwordx4 v[16:19], v7, s[44:47], 0 offen nt
    s_mov_b64 exec, 0
    s_cmp_eq_u32 s2, 0
    s_cbranch_scc1 HP0
    s_cmp_eq_u32 s2, 1
    s_cbranch_scc1 HP1
    s_cmp_eq_u32 s2, 2
    s_cbranch_scc1 HP2
    s_cmp_eq_u32 s2, 3
    s_cbranch_scc1 HP3
    s_cmp_eq_u32 s2, 4
    s_cbranch_scc1 HP4
    s_cmp_eq_u32 s2, 5
    s_cbranch_scc1 HP5
    s_cmp_eq_u32 s2, 6
    s_cbranch_scc1 HP6
    s_branch HP7
L_Pret:
    s_mov_b64 exec, -1
    s_mov_b32 s66, 0
    buffer_load_dwordx4 v[20:23], v3, s[44:47], s66 offen offset:0 nt
    buffer_load_dwordx4 v[24:27], v3, s[44:47], s66 offen offset:2048 nt
    buffer_load_dwordx4 v[84:87], v3, s[48:51], s66 offen offset:0 nt
    buffer_load_dwordx4 v[88:91], v3, s[48:51], s66 offen offset:2048 nt
    s_mul_i32 s66, s2, 16704
    v_add_u32 v250, s66, v1
    v_lshlrev_b32 v4, 6, v0
    v_add_u32 v4, 133632, v4
    v_lshrrev_b32 v2, 5, v0
    v_bfe_u32 v5, v0, 4, 1
    v_and_b32 v6, 3, v0
    v_bfe_u32 v7, v0, 2, 2
    v_lshl_add_u32 v251, v5, 2, v6
    v_mul_u32_u24 v251, 16704, v251
    v_sub_u32 v252, 3, v7
    v_mul_u32_u24 v252, 1040, v252
    s_lshl_b32 s66, s2, 7
    v_add3_u32 v251, v251, v252, s66
    v_lshl_add_u32 v251, v2, 3, v251
    v_lshl_add_u32 v5, v5, 2, v7
    v_lshrrev_b32 v7, 1, v5
    v_xor_b32 v6, v6, v7
    v_lshlrev_b32 v6, 4, v6
    v_lshl_add_u32 v6, v7, 8, v6
    v_and_b32 v5, 1, v5
    v_lshl_add_u32 v6, v5, 6, v6
    v_lshl_add_u32 v252, v2, 14, v6
    s_lshl_b32 s31, s63, 3
    s_add_u32 s31, s31, s2
    s_lshl_b32 s31, s31, 18
    s_lshl_b32 s67, s61, 10
    s_add_u32 s31, s31, s67
    s_add_u32 s31, s31, 16777216
    s_barrier
    s_mov_b32 s66, 4096
    buffer_load_dwordx4 v[28:31], v3, s[44:47], s66 offen offset:0 nt
    buffer_load_dwordx4 v[32:35], v3, s[44:47], s66 offen offset:2048 nt
    buffer_load_dwordx4 v[92:95], v3, s[48:51], s66 offen offset:0 nt
    buffer_load_dwordx4 v[96:99], v3, s[48:51], s66 offen offset:2048 nt
    s_mov_b32 s32, s4
    s_mov_b32 s33, s5
    s_mov_b32 s34, 4194304
    s_mov_b32 s35, 0x20000
    s_mov_b32 s56, s26
    s_mov_b32 s57, s27
    s_mov_b32 s58, 256
    s_mov_b32 s59, 0x20000
    s_mov_b32 s40, s28
    s_mov_b32 s41, s29
    s_mov_b32 s42, 50331648
    s_mov_b32 s43, 0x20000
    s_mov_b32 s30, 0xffff0000
    s_waitcnt vmcnt(4)
    s_barrier
    ds_read_b128 v[228:231], v4 offset:0
    ds_read_b128 v[232:235], v4 offset:16
    ds_read_b128 v[236:239], v4 offset:32
    ds_read_b128 v[240:243], v4 offset:48
    v_lshlrev_b32 v204, 16, v8
    v_and_b32 v205, s30, v8
    v_lshlrev_b32 v206, 16, v9
    v_and_b32 v207, s30, v9
    v_lshlrev_b32 v208, 16, v10
    v_and_b32 v209, s30, v10
    v_lshlrev_b32 v210, 16, v11
    v_and_b32 v211, s30, v11
    v_lshlrev_b32 v212, 16, v12
    v_and_b32 v213, s30, v12
    v_lshlrev_b32 v214, 16, v13
    v_and_b32 v215, s30, v13
    v_lshlrev_b32 v216, 16, v14
    v_and_b32 v217, s30, v14
    v_lshlrev_b32 v218, 16, v15
    v_and_b32 v219, s30, v15
    v_lshlrev_b32 v220, 16, v16
    v_and_b32 v221, s30, v16
    v_lshlrev_b32 v222, 16, v17
    v_and_b32 v223, s30, v17
    v_lshlrev_b32 v224, 16, v18
    v_and_b32 v225, s30, v18
    v_lshlrev_b32 v226, 16, v19
    v_and_b32 v227, s30, v19
    s_waitcnt lgkmcnt(0)
    v_lshlrev_b32 v148, 16, v228
    v_and_b32 v156, s30, v228
    v_lshlrev_b32 v164, 16, v229
    v_and_b32 v172, s30, v229
    v_lshlrev_b32 v149, 16, v230
    v_and_b32 v157, s30, v230
    v_lshlrev_b32 v165, 16, v231
    v_and_b32 v173, s30, v231
    v_lshlrev_b32 v150, 16, v232
    v_and_b32 v158, s30, v232
    v_lshlrev_b32 v166, 16, v233
    v_and_b32 v174, s30, v233
    v_lshlrev_b32 v151, 16, v234
    v_and_b32 v159, s30, v234
    v_lshlrev_b32 v167, 16, v235
    v_and_b32 v175, s30, v235
    v_lshlrev_b32 v152, 16, v236
    v_and_b32 v160, s30, v236
    v_lshlrev_b32 v168, 16, v237
    v_and_b32 v176, s30, v237
    v_lshlrev_b32 v153, 16, v238
    v_and_b32 v161, s30, v238
    v_lshlrev_b32 v169, 16, v239
    v_and_b32 v177, s30, v239
    v_lshlrev_b32 v154, 16, v240
    v_and_b32 v162, s30, v240
    v_lshlrev_b32 v170, 16, v241
    v_and_b32 v178, s30, v241
    v_lshlrev_b32 v155, 16, v242
    v_and_b32 v163, s30, v242
    v_lshlrev_b32 v171, 16, v243
    v_and_b32 v179, s30, v243
HP0:
    s_cbranch_execz L_Pret
    s_mov_b32 s66, 8192
    buffer_load_dwordx4 v[36:39], v3, s[44:47], s66 offen offset:0 nt
    v_lshlrev_b32 v228, 16, v20
    v_and_b32 v229, s30, v20
    v_lshlrev_b32 v230, 16, v21
    v_and_b32 v231, s30, v21
    v_lshlrev_b32 v232, 16, v22
    v_and_b32 v233, s30, v22
    v_lshlrev_b32 v234, 16, v23
    v_and_b32 v235, s30, v23
    v_mul_f32 v180, v204, v172
    v_mul_f32 v181, v205, v173
    v_mul_f32 v182, v206, v174
    v_mul_f32 v183, v207, v175
    v_mul_f32 v184, v208, v176
    v_mul_f32 v185, v209, v177
    v_mul_f32 v186, v210, v178
    v_mul_f32 v187, v211, v179
    v_fmac_f32 v180, v212, v164
    v_fmac_f32 v181, v213, v165
    v_fmac_f32 v182, v214, v166
    v_fmac_f32 v183, v215, v167
    v_fmac_f32 v184, v216, v168
    v_fmac_f32 v185, v217, v169
    v_fmac_f32 v186, v218, v170
    v_fmac_f32 v187, v219, v171
    v_fmac_f32 v180, v220, v156
    v_fmac_f32 v181, v221, v157
    v_fmac_f32 v182, v222, v158
    v_fmac_f32 v183, v223, v159
    v_fmac_f32 v184, v224, v160
    v_fmac_f32 v185, v225, v161
    v_fmac_f32 v186, v226, v162
    v_fmac_f32 v187, v227, v163
    buffer_load_dwordx4 v[40:43], v3, s[44:47], s66 offen offset:2048 nt
    v_fmac_f32 v180, v228, v148
    v_fmac_f32 v181, v229, v149
    v_fmac_f32 v182, v230, v150
    v_fmac_f32 v183, v231, v151
    v_fmac_f32 v184, v232, v152
    v_fmac_f32 v185, v233, v153
    v_fmac_f32 v186, v234, v154
    v_fmac_f32 v187, v235, v155
    v_lshlrev_b32 v188, 16, v84
    v_and_b32 v189, s30, v84
    v_lshlrev_b32 v190, 16, v85
    v_and_b32 v191, s30, v85
    v_lshlrev_b32 v192, 16, v86
    v_and_b32 v193, s30, v86
    v_lshlrev_b32 v194, 16, v87
    v_and_b32 v195, s30, v87
    v_mul_f32 v180, v180, v188
    v_mul_f32 v181, v181, v189
    v_mul_f32 v182, v182, v190
    v_mul_f32 v183, v183, v191
    v_mul_f32 v184, v184, v192
    v_mul_f32 v185, v185, v193
    v_mul_f32 v186, v186, v194
    v_mul_f32 v187, v187, v195
    v_cvt_pk_bf16_f32 v196, v180, v181
    v_cvt_pk_bf16_f32 v197, v182, v183
    v_cvt_pk_bf16_f32 v198, v184, v185
    v_cvt_pk_bf16_f32 v199, v186, v187
    ds_write_b128 v250, v[196:199] offset:0
    buffer_load_dwordx4 v[100:103], v3, s[48:51], s66 offen offset:0 nt
    v_lshlrev_b32 v236, 16, v24
    v_and_b32 v237, s30, v24
    v_lshlrev_b32 v238, 16, v25
    v_and_b32 v239, s30, v25
    v_lshlrev_b32 v240, 16, v26
    v_and_b32 v241, s30, v26
    v_lshlrev_b32 v242, 16, v27
    v_and_b32 v243, s30, v27
    v_mul_f32 v180, v212, v172
    v_mul_f32 v181, v213, v173
    v_mul_f32 v182, v214, v174
    v_mul_f32 v183, v215, v175
    v_mul_f32 v184, v216, v176
    v_mul_f32 v185, v217, v177
    v_mul_f32 v186, v218, v178
    v_mul_f32 v187, v219, v179
    v_fmac_f32 v180, v220, v164
    v_fmac_f32 v181, v221, v165
    v_fmac_f32 v182, v222, v166
    v_fmac_f32 v183, v223, v167
    v_fmac_f32 v184, v224, v168
    v_fmac_f32 v185, v225, v169
    v_fmac_f32 v186, v226, v170
    v_fmac_f32 v187, v227, v171
    v_fmac_f32 v180, v228, v156
    v_fmac_f32 v181, v229, v157
    v_fmac_f32 v182, v230, v158
    v_fmac_f32 v183, v231, v159
    v_fmac_f32 v184, v232, v160
    v_fmac_f32 v185, v233, v161
    v_fmac_f32 v186, v234, v162
    v_fmac_f32 v187, v235, v163
    buffer_load_dwordx4 v[104:107], v3, s[48:51], s66 offen offset:2048 nt
    v_fmac_f32 v180, v236, v148
    v_fmac_f32 v181, v237, v149
    v_fmac_f32 v182, v238, v150
    v_fmac_f32 v183, v239, v151
    v_fmac_f32 v184, v240, v152
    v_fmac_f32 v185, v241, v153
    v_fmac_f32 v186, v242, v154
    v_fmac_f32 v187, v243, v155
    v_lshlrev_b32 v188, 16, v88
    v_and_b32 v189, s30, v88
    v_lshlrev_b32 v190, 16, v89
    v_and_b32 v191, s30, v89
    v_lshlrev_b32 v192, 16, v90
    v_and_b32 v193, s30, v90
    v_lshlrev_b32 v194, 16, v91
    v_and_b32 v195, s30, v91
    v_mul_f32 v180, v180, v188
    v_mul_f32 v181, v181, v189
    v_mul_f32 v182, v182, v190
    v_mul_f32 v183, v183, v191
    v_mul_f32 v184, v184, v192
    v_mul_f32 v185, v185, v193
    v_mul_f32 v186, v186, v194
    v_mul_f32 v187, v187, v195
    v_cvt_pk_bf16_f32 v200, v180, v181
    v_cvt_pk_bf16_f32 v201, v182, v183
    v_cvt_pk_bf16_f32 v202, v184, v185
    v_cvt_pk_bf16_f32 v203, v186, v187
    ds_write_b128 v250, v[200:203] offset:1040
    s_waitcnt vmcnt(4)
    s_barrier
    s_mov_b32 s66, 12288
    buffer_load_dwordx4 v[44:47], v3, s[44:47], s66 offen offset:0 nt
    v_lshlrev_b32 v204, 16, v28
    v_and_b32 v205, s30, v28
    v_lshlrev_b32 v206, 16, v29
    v_and_b32 v207, s30, v29
    v_lshlrev_b32 v208, 16, v30
    v_and_b32 v209, s30, v30
    v_lshlrev_b32 v210, 16, v31
    v_and_b32 v211, s30, v31
    v_mul_f32 v180, v220, v172
    v_mul_f32 v181, v221, v173
    v_mul_f32 v182, v222, v174
    v_mul_f32 v183, v223, v175
    v_mul_f32 v184, v224, v176
    v_mul_f32 v185, v225, v177
    v_mul_f32 v186, v226, v178
    v_mul_f32 v187, v227, v179
    v_fmac_f32 v180, v228, v164
    v_fmac_f32 v181, v229, v165
    v_fmac_f32 v182, v230, v166
    v_fmac_f32 v183, v231, v167
    v_fmac_f32 v184, v232, v168
    v_fmac_f32 v185, v233, v169
    v_fmac_f32 v186, v234, v170
    v_fmac_f32 v187, v235, v171
    v_fmac_f32 v180, v236, v156
    v_fmac_f32 v181, v237, v157
    v_fmac_f32 v182, v238, v158
    v_fmac_f32 v183, v239, v159
    v_fmac_f32 v184, v240, v160
    v_fmac_f32 v185, v241, v161
    v_fmac_f32 v186, v242, v162
    v_fmac_f32 v187, v243, v163
    buffer_load_dwordx4 v[48:51], v3, s[44:47], s66 offen offset:2048 nt
    v_fmac_f32 v180, v204, v148
    v_fmac_f32 v181, v205, v149
    v_fmac_f32 v182, v206, v150
    v_fmac_f32 v183, v207, v151
    v_fmac_f32 v184, v208, v152
    v_fmac_f32 v185, v209, v153
    v_fmac_f32 v186, v210, v154
    v_fmac_f32 v187, v211, v155
    v_lshlrev_b32 v188, 16, v92
    v_and_b32 v189, s30, v92
    v_lshlrev_b32 v190, 16, v93
    v_and_b32 v191, s30, v93
    v_lshlrev_b32 v192, 16, v94
    v_and_b32 v193, s30, v94
    v_lshlrev_b32 v194, 16, v95
    v_and_b32 v195, s30, v95
    v_mul_f32 v180, v180, v188
    v_mul_f32 v181, v181, v189
    v_mul_f32 v182, v182, v190
    v_mul_f32 v183, v183, v191
    v_mul_f32 v184, v184, v192
    v_mul_f32 v185, v185, v193
    v_mul_f32 v186, v186, v194
    v_mul_f32 v187, v187, v195
    v_cvt_pk_bf16_f32 v196, v180, v181
    v_cvt_pk_bf16_f32 v197, v182, v183
    v_cvt_pk_bf16_f32 v198, v184, v185
    v_cvt_pk_bf16_f32 v199, v186, v187
    ds_write_b128 v250, v[196:199] offset:2080
    buffer_load_dwordx4 v[108:111], v3, s[48:51], s66 offen offset:0 nt
    v_lshlrev_b32 v212, 16, v32
    v_and_b32 v213, s30, v32
    v_lshlrev_b32 v214, 16, v33
    v_and_b32 v215, s30, v33
    v_lshlrev_b32 v216, 16, v34
    v_and_b32 v217, s30, v34
    v_lshlrev_b32 v218, 16, v35
    v_and_b32 v219, s30, v35
    v_mul_f32 v180, v228, v172
    v_mul_f32 v181, v229, v173
    v_mul_f32 v182, v230, v174
    v_mul_f32 v183, v231, v175
    v_mul_f32 v184, v232, v176
    v_mul_f32 v185, v233, v177
    v_mul_f32 v186, v234, v178
    v_mul_f32 v187, v235, v179
    v_fmac_f32 v180, v236, v164
    v_fmac_f32 v181, v237, v165
    v_fmac_f32 v182, v238, v166
    v_fmac_f32 v183, v239, v167
    v_fmac_f32 v184, v240, v168
    v_fmac_f32 v185, v241, v169
    v_fmac_f32 v186, v242, v170
    v_fmac_f32 v187, v243, v171
    v_fmac_f32 v180, v204, v156
    v_fmac_f32 v181, v205, v157
    v_fmac_f32 v182, v206, v158
    v_fmac_f32 v183, v207, v159
    v_fmac_f32 v184, v208, v160
    v_fmac_f32 v185, v209, v161
    v_fmac_f32 v186, v210, v162
    v_fmac_f32 v187, v211, v163
    buffer_load_dwordx4 v[112:115], v3, s[48:51], s66 offen offset:2048 nt
    v_fmac_f32 v180, v212, v148
    v_fmac_f32 v181, v213, v149
    v_fmac_f32 v182, v214, v150
    v_fmac_f32 v183, v215, v151
    v_fmac_f32 v184, v216, v152
    v_fmac_f32 v185, v217, v153
    v_fmac_f32 v186, v218, v154
    v_fmac_f32 v187, v219, v155
    v_lshlrev_b32 v188, 16, v96
    v_and_b32 v189, s30, v96
    v_lshlrev_b32 v190, 16, v97
    v_and_b32 v191, s30, v97
    v_lshlrev_b32 v192, 16, v98
    v_and_b32 v193, s30, v98
    v_lshlrev_b32 v194, 16, v99
    v_and_b32 v195, s30, v99
    v_mul_f32 v180, v180, v188
    v_mul_f32 v181, v181, v189
    v_mul_f32 v182, v182, v190
    v_mul_f32 v183, v183, v191
    v_mul_f32 v184, v184, v192
    v_mul_f32 v185, v185, v193
    v_mul_f32 v186, v186, v194
    v_mul_f32 v187, v187, v195
    v_cvt_pk_bf16_f32 v200, v180, v181
    v_cvt_pk_bf16_f32 v201, v182, v183
    v_cvt_pk_bf16_f32 v202, v184, v185
    v_cvt_pk_bf16_f32 v203, v186, v187
    ds_write_b128 v250, v[200:203] offset:3120
    s_waitcnt vmcnt(4)
    s_barrier
HP1:
    s_cbranch_execz L_Pret
    s_mov_b32 s66, 16384
    buffer_load_dwordx4 v[52:55], v3, s[44:47], s66 offen offset:0 nt
    v_lshlrev_b32 v220, 16, v36
    v_and_b32 v221, s30, v36
    v_lshlrev_b32 v222, 16, v37
    v_and_b32 v223, s30, v37
    v_lshlrev_b32 v224, 16, v38
    v_and_b32 v225, s30, v38
    v_lshlrev_b32 v226, 16, v39
    v_and_b32 v227, s30, v39
    v_mul_f32 v180, v236, v172
    v_mul_f32 v181, v237, v173
    v_mul_f32 v182, v238, v174
    v_mul_f32 v183, v239, v175
    v_mul_f32 v184, v240, v176
    v_mul_f32 v185, v241, v177
    v_mul_f32 v186, v242, v178
    v_mul_f32 v187, v243, v179
    v_fmac_f32 v180, v204, v164
    v_fmac_f32 v181, v205, v165
    v_fmac_f32 v182, v206, v166
    v_fmac_f32 v183, v207, v167
    v_fmac_f32 v184, v208, v168
    v_fmac_f32 v185, v209, v169
    v_fmac_f32 v186, v210, v170
    v_fmac_f32 v187, v211, v171
    v_fmac_f32 v180, v212, v156
    v_fmac_f32 v181, v213, v157
    v_fmac_f32 v182, v214, v158
    v_fmac_f32 v183, v215, v159
    v_fmac_f32 v184, v216, v160
    v_fmac_f32 v185, v217, v161
    v_fmac_f32 v186, v218, v162
    v_fmac_f32 v187, v219, v163
    buffer_load_dwordx4 v[56:59], v3, s[44:47], s66 offen offset:2048 nt
    v_fmac_f32 v180, v220, v148
    v_fmac_f32 v181, v221, v149
    v_fmac_f32 v182, v222, v150
    v_fmac_f32 v183, v223, v151
    v_fmac_f32 v184, v224, v152
    v_fmac_f32 v185, v225, v153
    v_fmac_f32 v186, v226, v154
    v_fmac_f32 v187, v227, v155
    v_lshlrev_b32 v188, 16, v100
    v_and_b32 v189, s30, v100
    v_lshlrev_b32 v190, 16, v101
    v_and_b32 v191, s30, v101
    v_lshlrev_b32 v192, 16, v102
    v_and_b32 v193, s30, v102
    v_lshlrev_b32 v194, 16, v103
    v_and_b32 v195, s30, v103
    v_mul_f32 v180, v180, v188
    v_mul_f32 v181, v181, v189
    v_mul_f32 v182, v182, v190
    v_mul_f32 v183, v183, v191
    v_mul_f32 v184, v184, v192
    v_mul_f32 v185, v185, v193
    v_mul_f32 v186, v186, v194
    v_mul_f32 v187, v187, v195
    v_cvt_pk_bf16_f32 v196, v180, v181
    v_cvt_pk_bf16_f32 v197, v182, v183
    v_cvt_pk_bf16_f32 v198, v184, v185
    v_cvt_pk_bf16_f32 v199, v186, v187
    ds_write_b128 v250, v[196:199] offset:4160
    buffer_load_dwordx4 v[116:119], v3, s[48:51], s66 offen offset:0 nt
    v_lshlrev_b32 v228, 16, v40
    v_and_b32 v229, s30, v40
    v_lshlrev_b32 v230, 16, v41
    v_and_b32 v231, s30, v41
    v_lshlrev_b32 v232, 16, v42
    v_and_b32 v233, s30, v42
    v_lshlrev_b32 v234, 16, v43
    v_and_b32 v235, s30, v43
    v_mul_f32 v180, v204, v172
    v_mul_f32 v181, v205, v173
    v_mul_f32 v182, v206, v174
    v_mul_f32 v183, v207, v175
    v_mul_f32 v184, v208, v176
    v_mul_f32 v185, v209, v177
    v_mul_f32 v186, v210, v178
    v_mul_f32 v187, v211, v179
    v_fmac_f32 v180, v212, v164
    v_fmac_f32 v181, v213, v165
    v_fmac_f32 v182, v214, v166
    v_fmac_f32 v183, v215, v167
    v_fmac_f32 v184, v216, v168
    v_fmac_f32 v185, v217, v169
    v_fmac_f32 v186, v218, v170
    v_fmac_f32 v187, v219, v171
    v_fmac_f32 v180, v220, v156
    v_fmac_f32 v181, v221, v157
    v_fmac_f32 v182, v222, v158
    v_fmac_f32 v183, v223, v159
    v_fmac_f32 v184, v224, v160
    v_fmac_f32 v185, v225, v161
    v_fmac_f32 v186, v226, v162
    v_fmac_f32 v187, v227, v163
    buffer_load_dwordx4 v[120:123], v3, s[48:51], s66 offen offset:2048 nt
    v_fmac_f32 v180, v228, v148
    v_fmac_f32 v181, v229, v149
    v_fmac_f32 v182, v230, v150
    v_fmac_f32 v183, v231, v151
    v_fmac_f32 v184, v232, v152
    v_fmac_f32 v185, v233, v153
    v_fmac_f32 v186, v234, v154
    v_fmac_f32 v187, v235, v155
    v_lshlrev_b32 v188, 16, v104
    v_and_b32 v189, s30, v104
    v_lshlrev_b32 v190, 16, v105
    v_and_b32 v191, s30, v105
    v_lshlrev_b32 v192, 16, v106
    v_and_b32 v193, s30, v106
    v_lshlrev_b32 v194, 16, v107
    v_and_b32 v195, s30, v107
    v_mul_f32 v180, v180, v188
    v_mul_f32 v181, v181, v189
    v_mul_f32 v182, v182, v190
    v_mul_f32 v183, v183, v191
    v_mul_f32 v184, v184, v192
    v_mul_f32 v185, v185, v193
    v_mul_f32 v186, v186, v194
    v_mul_f32 v187, v187, v195
    v_cvt_pk_bf16_f32 v200, v180, v181
    v_cvt_pk_bf16_f32 v201, v182, v183
    v_cvt_pk_bf16_f32 v202, v184, v185
    v_cvt_pk_bf16_f32 v203, v186, v187
    ds_write_b128 v250, v[200:203] offset:5200
    s_waitcnt vmcnt(4)
    s_barrier
HP2:
    s_cbranch_execz L_Pret
    s_mov_b32 s66, 20480
    buffer_load_dwordx4 v[60:63], v3, s[44:47], s66 offen offset:0 nt
    v_lshlrev_b32 v236, 16, v44
    v_and_b32 v237, s30, v44
    v_lshlrev_b32 v238, 16, v45
    v_and_b32 v239, s30, v45
    v_lshlrev_b32 v240, 16, v46
    v_and_b32 v241, s30, v46
    v_lshlrev_b32 v242, 16, v47
    v_and_b32 v243, s30, v47
    v_mul_f32 v180, v212, v172
    v_mul_f32 v181, v213, v173
    v_mul_f32 v182, v214, v174
    v_mul_f32 v183, v215, v175
    v_mul_f32 v184, v216, v176
    v_mul_f32 v185, v217, v177
    v_mul_f32 v186, v218, v178
    v_mul_f32 v187, v219, v179
    v_fmac_f32 v180, v220, v164
    v_fmac_f32 v181, v221, v165
    v_fmac_f32 v182, v222, v166
    v_fmac_f32 v183, v223, v167
    v_fmac_f32 v184, v224, v168
    v_fmac_f32 v185, v225, v169
    v_fmac_f32 v186, v226, v170
    v_fmac_f32 v187, v227, v171
    v_fmac_f32 v180, v228, v156
    v_fmac_f32 v181, v229, v157
    v_fmac_f32 v182, v230, v158
    v_fmac_f32 v183, v231, v159
    v_fmac_f32 v184, v232, v160
    v_fmac_f32 v185, v233, v161
    v_fmac_f32 v186, v234, v162
    v_fmac_f32 v187, v235, v163
    buffer_load_dwordx4 v[64:67], v3, s[44:47], s66 offen offset:2048 nt
    v_fmac_f32 v180, v236, v148
    v_fmac_f32 v181, v237, v149
    v_fmac_f32 v182, v238, v150
    v_fmac_f32 v183, v239, v151
    v_fmac_f32 v184, v240, v152
    v_fmac_f32 v185, v241, v153
    v_fmac_f32 v186, v242, v154
    v_fmac_f32 v187, v243, v155
    v_lshlrev_b32 v188, 16, v108
    v_and_b32 v189, s30, v108
    v_lshlrev_b32 v190, 16, v109
    v_and_b32 v191, s30, v109
    v_lshlrev_b32 v192, 16, v110
    v_and_b32 v193, s30, v110
    v_lshlrev_b32 v194, 16, v111
    v_and_b32 v195, s30, v111
    v_mul_f32 v180, v180, v188
    v_mul_f32 v181, v181, v189
    v_mul_f32 v182, v182, v190
    v_mul_f32 v183, v183, v191
    v_mul_f32 v184, v184, v192
    v_mul_f32 v185, v185, v193
    v_mul_f32 v186, v186, v194
    v_mul_f32 v187, v187, v195
    v_cvt_pk_bf16_f32 v196, v180, v181
    v_cvt_pk_bf16_f32 v197, v182, v183
    v_cvt_pk_bf16_f32 v198, v184, v185
    v_cvt_pk_bf16_f32 v199, v186, v187
    ds_write_b128 v250, v[196:199] offset:6240
    buffer_load_dwordx4 v[124:127], v3, s[48:51], s66 offen offset:0 nt
    v_lshlrev_b32 v204, 16, v48
    v_and_b32 v205, s30, v48
    v_lshlrev_b32 v206, 16, v49
    v_and_b32 v207, s30, v49
    v_lshlrev_b32 v208, 16, v50
    v_and_b32 v209, s30, v50
    v_lshlrev_b32 v210, 16, v51
    v_and_b32 v211, s30, v51
    v_mul_f32 v180, v220, v172
    v_mul_f32 v181, v221, v173
    v_mul_f32 v182, v222, v174
    v_mul_f32 v183, v223, v175
    v_mul_f32 v184, v224, v176
    v_mul_f32 v185, v225, v177
    v_mul_f32 v186, v226, v178
    v_mul_f32 v187, v227, v179
    v_fmac_f32 v180, v228, v164
    v_fmac_f32 v181, v229, v165
    v_fmac_f32 v182, v230, v166
    v_fmac_f32 v183, v231, v167
    v_fmac_f32 v184, v232, v168
    v_fmac_f32 v185, v233, v169
    v_fmac_f32 v186, v234, v170
    v_fmac_f32 v187, v235, v171
    v_fmac_f32 v180, v236, v156
    v_fmac_f32 v181, v237, v157
    v_fmac_f32 v182, v238, v158
    v_fmac_f32 v183, v239, v159
    v_fmac_f32 v184, v240, v160
    v_fmac_f32 v185, v241, v161
    v_fmac_f32 v186, v242, v162
    v_fmac_f32 v187, v243, v163
    buffer_load_dwordx4 v[128:131], v3, s[48:51], s66 offen offset:2048 nt
    v_fmac_f32 v180, v204, v148
    v_fmac_f32 v181, v205, v149
    v_fmac_f32 v182, v206, v150
    v_fmac_f32 v183, v207, v151
    v_fmac_f32 v184, v208, v152
    v_fmac_f32 v185, v209, v153
    v_fmac_f32 v186, v210, v154
    v_fmac_f32 v187, v211, v155
    v_lshlrev_b32 v188, 16, v112
    v_and_b32 v189, s30, v112
    v_lshlrev_b32 v190, 16, v113
    v_and_b32 v191, s30, v113
    v_lshlrev_b32 v192, 16, v114
    v_and_b32 v193, s30, v114
    v_lshlrev_b32 v194, 16, v115
    v_and_b32 v195, s30, v115
    v_mul_f32 v180, v180, v188
    v_mul_f32 v181, v181, v189
    v_mul_f32 v182, v182, v190
    v_mul_f32 v183, v183, v191
    v_mul_f32 v184, v184, v192
    v_mul_f32 v185, v185, v193
    v_mul_f32 v186, v186, v194
    v_mul_f32 v187, v187, v195
    v_cvt_pk_bf16_f32 v200, v180, v181
    v_cvt_pk_bf16_f32 v201, v182, v183
    v_cvt_pk_bf16_f32 v202, v184, v185
    v_cvt_pk_bf16_f32 v203, v186, v187
    ds_write_b128 v250, v[200:203] offset:7280
    s_waitcnt vmcnt(4) lgkmcnt(0)
    s_barrier
    ds_read_b64_tr_b16 v[84:85], v251 offset:4160
    ds_read_b64_tr_b16 v[86:87], v251 offset:0
    ds_read_b64_tr_b16 v[88:89], v251 offset:4176
    ds_read_b64_tr_b16 v[90:91], v251 offset:16
    ds_read_b64_tr_b16 v[92:93], v251 offset:4192
    ds_read_b64_tr_b16 v[94:95], v251 offset:32
    ds_read_b64_tr_b16 v[96:97], v251 offset:4208
    ds_read_b64_tr_b16 v[98:99], v251 offset:48
    ds_read_b64_tr_b16 v[100:101], v251 offset:4224
    ds_read_b64_tr_b16 v[102:103], v251 offset:64
    ds_read_b64_tr_b16 v[104:105], v251 offset:4240
    ds_read_b64_tr_b16 v[106:107], v251 offset:80
    ds_read_b64_tr_b16 v[108:109], v251 offset:4256
    ds_read_b64_tr_b16 v[110:111], v251 offset:96
    ds_read_b64_tr_b16 v[112:113], v251 offset:4272
    ds_read_b64_tr_b16 v[114:115], v251 offset:112
HP3:
    s_cbranch_execz L_Pret
    s_mov_b32 s66, 24576
    buffer_load_dwordx4 v[68:71], v3, s[44:47], s66 offen offset:0 nt
    v_lshlrev_b32 v212, 16, v52
    v_and_b32 v213, s30, v52
    v_lshlrev_b32 v214, 16, v53
    v_and_b32 v215, s30, v53
    v_lshlrev_b32 v216, 16, v54
    v_and_b32 v217, s30, v54
    v_lshlrev_b32 v218, 16, v55
    v_and_b32 v219, s30, v55
    v_mul_f32 v180, v228, v172
    v_mul_f32 v181, v229, v173
    v_mul_f32 v182, v230, v174
    v_mul_f32 v183, v231, v175
    v_mul_f32 v184, v232, v176
    v_mul_f32 v185, v233, v177
    v_mul_f32 v186, v234, v178
    v_mul_f32 v187, v235, v179
    v_fmac_f32 v180, v236, v164
    v_fmac_f32 v181, v237, v165
    v_fmac_f32 v182, v238, v166
    v_fmac_f32 v183, v239, v167
    v_fmac_f32 v184, v240, v168
    v_fmac_f32 v185, v241, v169
    v_fmac_f32 v186, v242, v170
    v_fmac_f32 v187, v243, v171
    v_fmac_f32 v180, v204, v156
    v_fmac_f32 v181, v205, v157
    v_fmac_f32 v182, v206, v158
    v_fmac_f32 v183, v207, v159
    v_fmac_f32 v184, v208, v160
    v_fmac_f32 v185, v209, v161
    v_fmac_f32 v186, v210, v162
    v_fmac_f32 v187, v211, v163
    buffer_load_dwordx4 v[72:75], v3, s[44:47], s66 offen offset:2048 nt
    v_fmac_f32 v180, v212, v148
    v_fmac_f32 v181, v213, v149
    v_fmac_f32 v182, v214, v150
    v_fmac_f32 v183, v215, v151
    v_fmac_f32 v184, v216, v152
    v_fmac_f32 v185, v217, v153
    v_fmac_f32 v186, v218, v154
    v_fmac_f32 v187, v219, v155
    v_lshlrev_b32 v188, 16, v116
    v_and_b32 v189, s30, v116
    v_lshlrev_b32 v190, 16, v117
    v_and_b32 v191, s30, v117
    v_lshlrev_b32 v192, 16, v118
    v_and_b32 v193, s30, v118
    v_lshlrev_b32 v194, 16, v119
    v_and_b32 v195, s30, v119
    v_mul_f32 v180, v180, v188
    v_mul_f32 v181, v181, v189
    v_mul_f32 v182, v182, v190
    v_mul_f32 v183, v183, v191
    v_mul_f32 v184, v184, v192
    v_mul_f32 v185, v185, v193
    v_mul_f32 v186, v186, v194
    v_mul_f32 v187, v187, v195
    v_cvt_pk_bf16_f32 v196, v180, v181
    v_cvt_pk_bf16_f32 v197, v182, v183
    v_cvt_pk_bf16_f32 v198, v184, v185
    v_cvt_pk_bf16_f32 v199, v186, v187
    ds_write_b128 v250, v[196:199] offset:8352
    buffer_load_dwordx4 v[132:135], v3, s[48:51], s66 offen offset:0 nt
    v_lshlrev_b32 v220, 16, v56
    v_and_b32 v221, s30, v56
    v_lshlrev_b32 v222, 16, v57
    v_and_b32 v223, s30, v57
    v_lshlrev_b32 v224, 16, v58
    v_and_b32 v225, s30, v58
    v_lshlrev_b32 v226, 16, v59
    v_and_b32 v227, s30, v59
    v_mul_f32 v180, v236, v172
    v_mul_f32 v181, v237, v173
    v_mul_f32 v182, v238, v174
    v_mul_f32 v183, v239, v175
    v_mul_f32 v184, v240, v176
    v_mul_f32 v185, v241, v177
    v_mul_f32 v186, v242, v178
    v_mul_f32 v187, v243, v179
    v_fmac_f32 v180, v204, v164
    v_fmac_f32 v181, v205, v165
    v_fmac_f32 v182, v206, v166
    v_fmac_f32 v183, v207, v167
    v_fmac_f32 v184, v208, v168
    v_fmac_f32 v185, v209, v169
    v_fmac_f32 v186, v210, v170
    v_fmac_f32 v187, v211, v171
    v_fmac_f32 v180, v212, v156
    v_fmac_f32 v181, v213, v157
    v_fmac_f32 v182, v214, v158
    v_fmac_f32 v183, v215, v159
    v_fmac_f32 v184, v216, v160
    v_fmac_f32 v185, v217, v161
    v_fmac_f32 v186, v218, v162
    v_fmac_f32 v187, v219, v163
    buffer_load_dwordx4 v[136:139], v3, s[48:51], s66 offen offset:2048 nt
    v_fmac_f32 v180, v220, v148
    v_fmac_f32 v181, v221, v149
    v_fmac_f32 v182, v222, v150
    v_fmac_f32 v183, v223, v151
    v_fmac_f32 v184, v224, v152
    v_fmac_f32 v185, v225, v153
    v_fmac_f32 v186, v226, v154
    v_fmac_f32 v187, v227, v155
    v_lshlrev_b32 v188, 16, v120
    v_and_b32 v189, s30, v120
    v_lshlrev_b32 v190, 16, v121
    v_and_b32 v191, s30, v121
    v_lshlrev_b32 v192, 16, v122
    v_and_b32 v193, s30, v122
    v_lshlrev_b32 v194, 16, v123
    v_and_b32 v195, s30, v123
    v_mul_f32 v180, v180, v188
    v_mul_f32 v181, v181, v189
    v_mul_f32 v182, v182, v190
    v_mul_f32 v183, v183, v191
    v_mul_f32 v184, v184, v192
    v_mul_f32 v185, v185, v193
    v_mul_f32 v186, v186, v194
    v_mul_f32 v187, v187, v195
    v_cvt_pk_bf16_f32 v200, v180, v181
    v_cvt_pk_bf16_f32 v201, v182, v183
    v_cvt_pk_bf16_f32 v202, v184, v185
    v_cvt_pk_bf16_f32 v203, v186, v187
    ds_write_b128 v250, v[200:203] offset:9392
    s_waitcnt vmcnt(4)
    s_barrier
HP4:
    s_cbranch_execz L_Pret
    s_mov_b32 s66, 28672
    buffer_load_dwordx4 v[76:79], v3, s[44:47], s66 offen offset:0 nt
    v_lshlrev_b32 v228, 16, v60
    v_and_b32 v229, s30, v60
    v_lshlrev_b32 v230, 16, v61
    v_and_b32 v231, s30, v61
    v_lshlrev_b32 v232, 16, v62
    v_and_b32 v233, s30, v62
    v_lshlrev_b32 v234, 16, v63
    v_and_b32 v235, s30, v63
    v_mul_f32 v180, v204, v172
    v_mul_f32 v181, v205, v173
    v_mul_f32 v182, v206, v174
    v_mul_f32 v183, v207, v175
    v_mul_f32 v184, v208, v176
    v_mul_f32 v185, v209, v177
    v_mul_f32 v186, v210, v178
    v_mul_f32 v187, v211, v179
    v_fmac_f32 v180, v212, v164
    v_fmac_f32 v181, v213, v165
    v_fmac_f32 v182, v214, v166
    v_fmac_f32 v183, v215, v167
    v_fmac_f32 v184, v216, v168
    v_fmac_f32 v185, v217, v169
    v_fmac_f32 v186, v218, v170
    v_fmac_f32 v187, v219, v171
    v_fmac_f32 v180, v220, v156
    v_fmac_f32 v181, v221, v157
    v_fmac_f32 v182, v222, v158
    v_fmac_f32 v183, v223, v159
    v_fmac_f32 v184, v224, v160
    v_fmac_f32 v185, v225, v161
    v_fmac_f32 v186, v226, v162
    v_fmac_f32 v187, v227, v163
    buffer_load_dwordx4 v[80:83], v3, s[44:47], s66 offen offset:2048 nt
    v_fmac_f32 v180, v228, v148
    v_fmac_f32 v181, v229, v149
    v_fmac_f32 v182, v230, v150
    v_fmac_f32 v183, v231, v151
    v_fmac_f32 v184, v232, v152
    v_fmac_f32 v185, v233, v153
    v_fmac_f32 v186, v234, v154
    v_fmac_f32 v187, v235, v155
    v_lshlrev_b32 v188, 16, v124
    v_and_b32 v189, s30, v124
    v_lshlrev_b32 v190, 16, v125
    v_and_b32 v191, s30, v125
    v_lshlrev_b32 v192, 16, v126
    v_and_b32 v193, s30, v126
    v_lshlrev_b32 v194, 16, v127
    v_and_b32 v195, s30, v127
    v_mul_f32 v180, v180, v188
    v_mul_f32 v181, v181, v189
    v_mul_f32 v182, v182, v190
    v_mul_f32 v183, v183, v191
    v_mul_f32 v184, v184, v192
    v_mul_f32 v185, v185, v193
    v_mul_f32 v186, v186, v194
    v_mul_f32 v187, v187, v195
    v_cvt_pk_bf16_f32 v196, v180, v181
    v_cvt_pk_bf16_f32 v197, v182, v183
    v_cvt_pk_bf16_f32 v198, v184, v185
    v_cvt_pk_bf16_f32 v199, v186, v187
    ds_write_b128 v250, v[196:199] offset:10432
    buffer_load_dwordx4 v[140:143], v3, s[48:51], s66 offen offset:0 nt
    v_lshlrev_b32 v236, 16, v64
    v_and_b32 v237, s30, v64
    v_lshlrev_b32 v238, 16, v65
    v_and_b32 v239, s30, v65
    v_lshlrev_b32 v240, 16, v66
    v_and_b32 v241, s30, v66
    v_lshlrev_b32 v242, 16, v67
    v_and_b32 v243, s30, v67
    v_mul_f32 v180, v212, v172
    v_mul_f32 v181, v213, v173
    v_mul_f32 v182, v214, v174
    v_mul_f32 v183, v215, v175
    v_mul_f32 v184, v216, v176
    v_mul_f32 v185, v217, v177
    v_mul_f32 v186, v218, v178
    v_mul_f32 v187, v219, v179
    v_fmac_f32 v180, v220, v164
    v_fmac_f32 v181, v221, v165
    v_fmac_f32 v182, v222, v166
    v_fmac_f32 v183, v223, v167
    v_fmac_f32 v184, v224, v168
    v_fmac_f32 v185, v225, v169
    v_fmac_f32 v186, v226, v170
    v_fmac_f32 v187, v227, v171
    v_fmac_f32 v180, v228, v156
    v_fmac_f32 v181, v229, v157
    v_fmac_f32 v182, v230, v158
    v_fmac_f32 v183, v231, v159
    v_fmac_f32 v184, v232, v160
    v_fmac_f32 v185, v233, v161
    v_fmac_f32 v186, v234, v162
    v_fmac_f32 v187, v235, v163
    buffer_load_dwordx4 v[144:147], v3, s[48:51], s66 offen offset:2048 nt
    v_fmac_f32 v180, v236, v148
    v_fmac_f32 v181, v237, v149
    v_fmac_f32 v182, v238, v150
    v_fmac_f32 v183, v239, v151
    v_fmac_f32 v184, v240, v152
    v_fmac_f32 v185, v241, v153
    v_fmac_f32 v186, v242, v154
    v_fmac_f32 v187, v243, v155
    v_lshlrev_b32 v188, 16, v128
    v_and_b32 v189, s30, v128
    v_lshlrev_b32 v190, 16, v129
    v_and_b32 v191, s30, v129
    v_lshlrev_b32 v192, 16, v130
    v_and_b32 v193, s30, v130
    v_lshlrev_b32 v194, 16, v131
    v_and_b32 v195, s30, v131
    v_mul_f32 v180, v180, v188
    v_mul_f32 v181, v181, v189
    v_mul_f32 v182, v182, v190
    v_mul_f32 v183, v183, v191
    v_mul_f32 v184, v184, v192
    v_mul_f32 v185, v185, v193
    v_mul_f32 v186, v186, v194
    v_mul_f32 v187, v187, v195
    v_cvt_pk_bf16_f32 v200, v180, v181
    v_cvt_pk_bf16_f32 v201, v182, v183
    v_cvt_pk_bf16_f32 v202, v184, v185
    v_cvt_pk_bf16_f32 v203, v186, v187
    ds_write_b128 v250, v[200:203] offset:11472
    s_waitcnt vmcnt(4)
    s_barrier
HP5:
    s_cbranch_execz L_Pret
    s_waitcnt lgkmcnt(0)
    s_add_u32 s67, s31, 0
    buffer_store_dwordx4 v[84:87], v252, s[40:43], s67 offen offset:0 sc1
    v_lshlrev_b32 v204, 16, v68
    v_and_b32 v205, s30, v68
    v_lshlrev_b32 v206, 16, v69
    v_and_b32 v207, s30, v69
    v_lshlrev_b32 v208, 16, v70
    v_and_b32 v209, s30, v70
    v_lshlrev_b32 v210, 16, v71
    v_and_b32 v211, s30, v71
    v_mul_f32 v180, v220, v172
    v_mul_f32 v181, v221, v173
    v_mul_f32 v182, v222, v174
    v_mul_f32 v183, v223, v175
    v_mul_f32 v184, v224, v176
    v_mul_f32 v185, v225, v177
    v_mul_f32 v186, v226, v178
    v_mul_f32 v187, v227, v179
    v_fmac_f32 v180, v228, v164
    v_fmac_f32 v181, v229, v165
    v_fmac_f32 v182, v230, v166
    v_fmac_f32 v183, v231, v167
    v_fmac_f32 v184, v232, v168
    v_fmac_f32 v185, v233, v169
    v_fmac_f32 v186, v234, v170
    v_fmac_f32 v187, v235, v171
    v_fmac_f32 v180, v236, v156
    v_fmac_f32 v181, v237, v157
    v_fmac_f32 v182, v238, v158
    v_fmac_f32 v183, v239, v159
    v_fmac_f32 v184, v240, v160
    v_fmac_f32 v185, v241, v161
    v_fmac_f32 v186, v242, v162
    v_fmac_f32 v187, v243, v163
    s_add_u32 s67, s31, 32768
    buffer_store_dwordx4 v[88:91], v252, s[40:43], s67 offen offset:0 sc1
    v_fmac_f32 v180, v204, v148
    v_fmac_f32 v181, v205, v149
    v_fmac_f32 v182, v206, v150
    v_fmac_f32 v183, v207, v151
    v_fmac_f32 v184, v208, v152
    v_fmac_f32 v185, v209, v153
    v_fmac_f32 v186, v210, v154
    v_fmac_f32 v187, v211, v155
    v_lshlrev_b32 v188, 16, v132
    v_and_b32 v189, s30, v132
    v_lshlrev_b32 v190, 16, v133
    v_and_b32 v191, s30, v133
    v_lshlrev_b32 v192, 16, v134
    v_and_b32 v193, s30, v134
    v_lshlrev_b32 v194, 16, v135
    v_and_b32 v195, s30, v135
    v_mul_f32 v180, v180, v188
    v_mul_f32 v181, v181, v189
    v_mul_f32 v182, v182, v190
    v_mul_f32 v183, v183, v191
    v_mul_f32 v184, v184, v192
    v_mul_f32 v185, v185, v193
    v_mul_f32 v186, v186, v194
    v_mul_f32 v187, v187, v195
    v_cvt_pk_bf16_f32 v196, v180, v181
    v_cvt_pk_bf16_f32 v197, v182, v183
    v_cvt_pk_bf16_f32 v198, v184, v185
    v_cvt_pk_bf16_f32 v199, v186, v187
    ds_write_b128 v250, v[196:199] offset:12512
    s_add_u32 s67, s31, 65536
    buffer_store_dwordx4 v[92:95], v252, s[40:43], s67 offen offset:0 sc1
    v_lshlrev_b32 v212, 16, v72
    v_and_b32 v213, s30, v72
    v_lshlrev_b32 v214, 16, v73
    v_and_b32 v215, s30, v73
    v_lshlrev_b32 v216, 16, v74
    v_and_b32 v217, s30, v74
    v_lshlrev_b32 v218, 16, v75
    v_and_b32 v219, s30, v75
    v_mul_f32 v180, v228, v172
    v_mul_f32 v181, v229, v173
    v_mul_f32 v182, v230, v174
    v_mul_f32 v183, v231, v175
    v_mul_f32 v184, v232, v176
    v_mul_f32 v185, v233, v177
    v_mul_f32 v186, v234, v178
    v_mul_f32 v187, v235, v179
    v_fmac_f32 v180, v236, v164
    v_fmac_f32 v181, v237, v165
    v_fmac_f32 v182, v238, v166
    v_fmac_f32 v183, v239, v167
    v_fmac_f32 v184, v240, v168
    v_fmac_f32 v185, v241, v169
    v_fmac_f32 v186, v242, v170
    v_fmac_f32 v187, v243, v171
    v_fmac_f32 v180, v204, v156
    v_fmac_f32 v181, v205, v157
    v_fmac_f32 v182, v206, v158
    v_fmac_f32 v183, v207, v159
    v_fmac_f32 v184, v208, v160
    v_fmac_f32 v185, v209, v161
    v_fmac_f32 v186, v210, v162
    v_fmac_f32 v187, v211, v163
    s_add_u32 s67, s31, 98304
    buffer_store_dwordx4 v[96:99], v252, s[40:43], s67 offen offset:0 sc1
    v_fmac_f32 v180, v212, v148
    v_fmac_f32 v181, v213, v149
    v_fmac_f32 v182, v214, v150
    v_fmac_f32 v183, v215, v151
    v_fmac_f32 v184, v216, v152
    v_fmac_f32 v185, v217, v153
    v_fmac_f32 v186, v218, v154
    v_fmac_f32 v187, v219, v155
    v_lshlrev_b32 v188, 16, v136
    v_and_b32 v189, s30, v136
    v_lshlrev_b32 v190, 16, v137
    v_and_b32 v191, s30, v137
    v_lshlrev_b32 v192, 16, v138
    v_and_b32 v193, s30, v138
    v_lshlrev_b32 v194, 16, v139
    v_and_b32 v195, s30, v139
    v_mul_f32 v180, v180, v188
    v_mul_f32 v181, v181, v189
    v_mul_f32 v182, v182, v190
    v_mul_f32 v183, v183, v191
    v_mul_f32 v184, v184, v192
    v_mul_f32 v185, v185, v193
    v_mul_f32 v186, v186, v194
    v_mul_f32 v187, v187, v195
    v_cvt_pk_bf16_f32 v200, v180, v181
    v_cvt_pk_bf16_f32 v201, v182, v183
    v_cvt_pk_bf16_f32 v202, v184, v185
    v_cvt_pk_bf16_f32 v203, v186, v187
    ds_write_b128 v250, v[200:203] offset:13552
    s_waitcnt vmcnt(4)
    v_mov_b32 v8, 0
    v_mov_b32 v9, 0
    v_mov_b32 v10, 0
    v_mov_b32 v11, 0
    s_lshl_b32 s67, s61, 1
    s_add_u32 s67, s67, s63
    s_lshl_b32 s67, s67, 3
    s_add_u32 s67, s67, s2
    s_lshl_b32 s67, s67, 8
    s_add_u32 s67, s67, 26214400
    s_mov_b64 exec, 0xffff
    buffer_store_dwordx4 v[8:11], v1, s[40:43], s67 offen sc1
    s_mov_b64 exec, -1
HP6:
    s_cbranch_execz L_Pret
    s_add_u32 s67, s31, 131072
    buffer_store_dwordx4 v[100:103], v252, s[40:43], s67 offen offset:0 sc1
    v_lshlrev_b32 v220, 16, v76
    v_and_b32 v221, s30, v76
    v_lshlrev_b32 v222, 16, v77
    v_and_b32 v223, s30, v77
    v_lshlrev_b32 v224, 16, v78
    v_and_b32 v225, s30, v78
    v_lshlrev_b32 v226, 16, v79
    v_and_b32 v227, s30, v79
    v_mul_f32 v180, v236, v172
    v_mul_f32 v181, v237, v173
    v_mul_f32 v182, v238, v174
    v_mul_f32 v183, v239, v175
    v_mul_f32 v184, v240, v176
    v_mul_f32 v185, v241, v177
    v_mul_f32 v186, v242, v178
    v_mul_f32 v187, v243, v179
    v_fmac_f32 v180, v204, v164
    v_fmac_f32 v181, v205, v165
    v_fmac_f32 v182, v206, v166
    v_fmac_f32 v183, v207, v167
    v_fmac_f32 v184, v208, v168
    v_fmac_f32 v185, v209, v169
    v_fmac_f32 v186, v210, v170
    v_fmac_f32 v187, v211, v171
    v_fmac_f32 v180, v212, v156
    v_fmac_f32 v181, v213, v157
    v_fmac_f32 v182, v214, v158
    v_fmac_f32 v183, v215, v159
    v_fmac_f32 v184, v216, v160
    v_fmac_f32 v185, v217, v161
    v_fmac_f32 v186, v218, v162
    v_fmac_f32 v187, v219, v163
    s_add_u32 s67, s31, 163840
    buffer_store_dwordx4 v[104:107], v252, s[40:43], s67 offen offset:0 sc1
    v_fmac_f32 v180, v220, v148
    v_fmac_f32 v181, v221, v149
    v_fmac_f32 v182, v222, v150
    v_fmac_f32 v183, v223, v151
    v_fmac_f32 v184, v224, v152
    v_fmac_f32 v185, v225, v153
    v_fmac_f32 v186, v226, v154
    v_fmac_f32 v187, v227, v155
    v_lshlrev_b32 v188, 16, v140
    v_and_b32 v189, s30, v140
    v_lshlrev_b32 v190, 16, v141
    v_and_b32 v191, s30, v141
    v_lshlrev_b32 v192, 16, v142
    v_and_b32 v193, s30, v142
    v_lshlrev_b32 v194, 16, v143
    v_and_b32 v195, s30, v143
    v_mul_f32 v180, v180, v188
    v_mul_f32 v181, v181, v189
    v_mul_f32 v182, v182, v190
    v_mul_f32 v183, v183, v191
    v_mul_f32 v184, v184, v192
    v_mul_f32 v185, v185, v193
    v_mul_f32 v186, v186, v194
    v_mul_f32 v187, v187, v195
    v_cvt_pk_bf16_f32 v196, v180, v181
    v_cvt_pk_bf16_f32 v197, v182, v183
    v_cvt_pk_bf16_f32 v198, v184, v185
    v_cvt_pk_bf16_f32 v199, v186, v187
    ds_write_b128 v250, v[196:199] offset:14592
    s_add_u32 s67, s31, 196608
    buffer_store_dwordx4 v[108:111], v252, s[40:43], s67 offen offset:0 sc1
    v_lshlrev_b32 v228, 16, v80
    v_and_b32 v229, s30, v80
    v_lshlrev_b32 v230, 16, v81
    v_and_b32 v231, s30, v81
    v_lshlrev_b32 v232, 16, v82
    v_and_b32 v233, s30, v82
    v_lshlrev_b32 v234, 16, v83
    v_and_b32 v235, s30, v83
    v_mul_f32 v180, v204, v172
    v_mul_f32 v181, v205, v173
    v_mul_f32 v182, v206, v174
    v_mul_f32 v183, v207, v175
    v_mul_f32 v184, v208, v176
    v_mul_f32 v185, v209, v177
    v_mul_f32 v186, v210, v178
    v_mul_f32 v187, v211, v179
    v_fmac_f32 v180, v212, v164
    v_fmac_f32 v181, v213, v165
    v_fmac_f32 v182, v214, v166
    v_fmac_f32 v183, v215, v167
    v_fmac_f32 v184, v216, v168
    v_fmac_f32 v185, v217, v169
    v_fmac_f32 v186, v218, v170
    v_fmac_f32 v187, v219, v171
    v_fmac_f32 v180, v220, v156
    v_fmac_f32 v181, v221, v157
    v_fmac_f32 v182, v222, v158
    v_fmac_f32 v183, v223, v159
    v_fmac_f32 v184, v224, v160
    v_fmac_f32 v185, v225, v161
    v_fmac_f32 v186, v226, v162
    v_fmac_f32 v187, v227, v163
    s_add_u32 s67, s31, 229376
    buffer_store_dwordx4 v[112:115], v252, s[40:43], s67 offen offset:0 sc1
    v_fmac_f32 v180, v228, v148
    v_fmac_f32 v181, v229, v149
    v_fmac_f32 v182, v230, v150
    v_fmac_f32 v183, v231, v151
    v_fmac_f32 v184, v232, v152
    v_fmac_f32 v185, v233, v153
    v_fmac_f32 v186, v234, v154
    v_fmac_f32 v187, v235, v155
    v_lshlrev_b32 v188, 16, v144
    v_and_b32 v189, s30, v144
    v_lshlrev_b32 v190, 16, v145
    v_and_b32 v191, s30, v145
    v_lshlrev_b32 v192, 16, v146
    v_and_b32 v193, s30, v146
    v_lshlrev_b32 v194, 16, v147
    v_and_b32 v195, s30, v147
    v_mul_f32 v180, v180, v188
    v_mul_f32 v181, v181, v189
    v_mul_f32 v182, v182, v190
    v_mul_f32 v183, v183, v191
    v_mul_f32 v184, v184, v192
    v_mul_f32 v185, v185, v193
    v_mul_f32 v186, v186, v194
    v_mul_f32 v187, v187, v195
    v_cvt_pk_bf16_f32 v200, v180, v181
    v_cvt_pk_bf16_f32 v201, v182, v183
    v_cvt_pk_bf16_f32 v202, v184, v185
    v_cvt_pk_bf16_f32 v203, v186, v187
    ds_write_b128 v250, v[200:203] offset:15632
HP7:
    s_cbranch_execz L_Pret
    s_waitcnt lgkmcnt(0)
    s_barrier
    ds_read_b64_tr_b16 v[84:85], v251 offset:12512
    ds_read_b64_tr_b16 v[86:87], v251 offset:8352
    ds_read_b64_tr_b16 v[88:89], v251 offset:12528
    ds_read_b64_tr_b16 v[90:91], v251 offset:8368
    ds_read_b64_tr_b16 v[92:93], v251 offset:12544
    ds_read_b64_tr_b16 v[94:95], v251 offset:8384
    ds_read_b64_tr_b16 v[96:97], v251 offset:12560
    ds_read_b64_tr_b16 v[98:99], v251 offset:8400
    ds_read_b64_tr_b16 v[100:101], v251 offset:12576
    ds_read_b64_tr_b16 v[102:103], v251 offset:8416
    ds_read_b64_tr_b16 v[104:105], v251 offset:12592
    ds_read_b64_tr_b16 v[106:107], v251 offset:8432
    ds_read_b64_tr_b16 v[108:109], v251 offset:12608
    ds_read_b64_tr_b16 v[110:111], v251 offset:8448
    ds_read_b64_tr_b16 v[112:113], v251 offset:12624
    ds_read_b64_tr_b16 v[114:115], v251 offset:8464
    s_waitcnt lgkmcnt(14)
    s_add_u32 s67, s31, 0
    buffer_store_dwordx4 v[84:87], v252, s[40:43], s67 offen offset:128 sc1
    s_waitcnt lgkmcnt(12)
    s_add_u32 s67, s31, 32768
    buffer_store_dwordx4 v[88:91], v252, s[40:43], s67 offen offset:128 sc1
    s_waitcnt lgkmcnt(10)
    s_add_u32 s67, s31, 65536
    buffer_store_dwordx4 v[92:95], v252, s[40:43], s67 offen offset:128 sc1
    s_waitcnt lgkmcnt(8)
    s_add_u32 s67, s31, 98304
    buffer_store_dwordx4 v[96:99], v252, s[40:43], s67 offen offset:128 sc1
    s_waitcnt lgkmcnt(6)
    s_add_u32 s67, s31, 131072
    buffer_store_dwordx4 v[100:103], v252, s[40:43], s67 offen offset:128 sc1
    s_waitcnt lgkmcnt(4)
    s_add_u32 s67, s31, 163840
    buffer_store_dwordx4 v[104:107], v252, s[40:43], s67 offen offset:128 sc1
    s_waitcnt lgkmcnt(2)
    s_add_u32 s67, s31, 196608
    buffer_store_dwordx4 v[108:111], v252, s[40:43], s67 offen offset:128 sc1
    s_waitcnt lgkmcnt(0)
    s_add_u32 s67, s31, 229376
    buffer_store_dwordx4 v[112:115], v252, s[40:43], s67 offen offset:128 sc1
    s_cmp_lt_u32 s2, 4
    s_cbranch_scc1 L_Pa
    s_branch L_cs
L_csret:
    s_call_b64 s[0:1], L_dg
    v_mov_b32 v33, 0
    s_waitcnt vmcnt(0)
    s_barrier
    buffer_load_dwordx4 v[64:67], v1, s[44:47], s6 offen offset:0 nt
    buffer_load_dwordx4 v[68:71], v1, s[44:47], s6 offen offset:1024 nt
    buffer_load_dwordx4 v[72:75], v1, s[44:47], s6 offen offset:2048 nt
    buffer_load_dwordx4 v[76:79], v1, s[44:47], s6 offen offset:3072 nt
    buffer_load_dwordx4 v[208:211], v1, s[52:55], 0 offen offset:0
    buffer_load_dwordx4 v[212:215], v1, s[52:55], 0 offen offset:1024
    s_lshl_b32 s66, s61, 2
    s_add_u32 s66, s66, s65
    s_lshl_b32 s66, s66, 3
    s_add_u32 s66, s66, s64
    s_lshl_b32 s66, s66, 8
    s_mul_i32 s25, s63, 3670016
    s_add_u32 s25, s25, s66
    s_lshl_b32 s66, s64, 2
    s_add_u32 s66, s66, 14
    v_lshrrev_b32 v35, 1, v0
    v_add_u32 v35, s66, v35
    v_subrev_u32 v34, 28, v35
    v_min_u32 v35, v35, v34
    v_lshlrev_b32 v35, 10, v35
    v_and_or_b32 v35, v0, 1, v35
    v_lshlrev_b32 v35, 7, v35
    s_mov_b32 exec_lo, 268435455
    s_mov_b32 exec_hi, 0
    buffer_load_dword v36, v35, s[48:51], s25 offen
    s_mov_b64 exec, -1
    s_waitcnt vmcnt(0)
    s_call_b64 s[0:1], L_ho
    s_call_b64 s[0:1], L_ho2
    s_call_b64 s[0:1], L_hw
    s_call_b64 s[0:1], L_hw2
    s_branch L_Btail
L_Pa:
    s_waitcnt vmcnt(0)
    s_barrier
    s_cmp_lg_u32 s2, 1
    s_cbranch_scc1 L_only22
    s_mov_b64 exec, 0
    s_branch HQ0
L_Qret:
    s_mov_b64 exec, -1
L_only22:
    s_cmp_lg_u32 s2, 0
    s_cbranch_scc1 L_only23
    v_mov_b32 v2, 1
    s_mov_b64 exec, 1
    buffer_atomic_add v2, off, s[56:59], 0 sc0 sc1
    s_waitcnt vmcnt(0)
    v_readfirstlane_b32 s67, v2
    s_nop 1
    s_cmp_lg_u32 s67, 31
    s_cbranch_scc1 L_only24
    buffer_store_dword v2, off, s[56:59], 0 offset:128 sc1
L_only24:
    s_mov_b64 exec, -1
L_only23:
    s_branch L_A1
L_end:
    s_endpgm
.section .rodata,"a"
.p2align 6
.amdhsa_kernel gated_mix__ssm_conv_h3__dense_activation_relu__prompt_kernel
  .amdhsa_next_free_vgpr 256
  .amdhsa_next_free_sgpr 102
  .amdhsa_accum_offset 256
  .amdhsa_group_segment_fixed_size 0
  .amdhsa_kernarg_size 104
  .amdhsa_user_sgpr_count 2
  .amdhsa_user_sgpr_kernarg_segment_ptr 1
  .amdhsa_system_sgpr_workgroup_id_x 1
  .amdhsa_float_denorm_mode_32 3
.end_amdhsa_kernel
```
